```python
import torch

def _softmax(x, axis=-1):
    return torch.softmax(x, dim=axis)
def _gelu(x):
    return torch.nn.functional.gelu(x, approximate="tanh")
def _silu(x):
    return torch.nn.functional.silu(x)
def _sigmoid(x):
    return torch.sigmoid(x)
def _layernorm(x, axis=-1, eps=1e-5):
    m = x.mean(dim=axis, keepdim=True)
    v = x.var(dim=axis, keepdim=True, unbiased=False)
    return (x - m) / torch.sqrt(v + eps)
def _scatter_add(tgt, idx, src, axis=0):
    return tgt.clone().index_add_(axis, idx, src)
def _segment_sum(src, seg, n):
    out = torch.zeros((n,) + src.shape[1:], dtype=src.dtype)
    return out.index_add_(0, seg, src)
def _pad(x, pw):
    flat = tuple(v for pair in reversed(pw) for v in pair)
    return torch.nn.functional.pad(x, flat)

kernel_name = 'standalone__normalfloat_lut_nf4__prompt'

def setup_inputs():

    _w = (lambda a: (lambda t: t.to(torch.bfloat16) if t.is_floating_point() else t)(torch.as_tensor(a)))
    B, S, D, F = 1, 2048, 576, 4608
    G = 128 if 128 > 0 else D
    D = (D // G) * G
    ng = D // G
    qw = torch.randint(0, 16, (D, F)).to(torch.int64)
    return {
        "x": _w((lambda *s: torch.randn(*s, dtype=torch.bfloat16) * 0.05)(B, S, D)),
        "qw": _w(qw),
        "absmax": _w(torch.abs((lambda *s: torch.randn(*s, dtype=torch.bfloat16) * 0.05)(ng, F)).to(float) + 0.01),
    }

def reference(x, qw, absmax):
    NF4 = torch.as_tensor([
        -1.0, -0.6961928009986877, -0.5250730514526367, -0.39491748809814453,
        -0.28444138169288635, -0.18477343022823334, -0.09105003625154495, 0.0,
        0.07958029955625534, 0.16093020141124725, 0.24611230194568634,
        0.33791524171829224, 0.44070982933044434, 0.5626170039176941,
        0.7229568362236023, 1.0,
    ])
    D, F = qw.shape[0], qw.shape[1]
    ng = absmax.shape[0]
    G = D // ng
    w = (lambda x, dt: x.to(dt))(NF4[qw], x.dtype)
    s = (lambda x, n, axis: torch.repeat_interleave(x, n, dim=axis))(absmax, G, axis=0)
    w = w * s
    return torch.einsum("bsd,df->bsf", x, w)
```

```asm
; @launch grid=(256,1,1) block=(512,1,1) lds=163840
.amdgcn_target "amdgcn-amd-amdhsa--gfx950"
.text
.globl standalone__normalfloat_lut_nf4__prompt_kernel
.p2align 8
.type standalone__normalfloat_lut_nf4__prompt_kernel,@function
standalone__normalfloat_lut_nf4__prompt_kernel:
    s_load_dwordx2 s[20:21], s[0:1], 8
    s_getpc_b64 s[6:7]
L_pc:
    s_bfe_u32 s8, s2, 0x40003
    s_min_u32 s8, s8, (L_last-L_pc)>>11
    s_lshl_b32 s8, s8, 11
    v_lshl_add_u32 v4, v0, 4, s8
    v_mov_b32 v5, 0
    v_readfirstlane_b32 s42, v0
    v_lshl_add_u64 v[4:5], v[4:5], 0, s[6:7]
    s_cmp_ge_u32 s42, 128
    s_cbranch_scc1 L_nopf
    global_load_dwordx4 v[124:127], v[4:5], off offset:-12
L_nopf:
    s_load_dwordx2 s[16:17], s[0:1], 0
    s_lshr_b32 s42, s42, 6
    s_cmp_lt_u32 s42, 4
    s_cbranch_scc1 L_cons
    s_load_dwordx2 s[24:25], s[0:1], 16
    s_and_b32 s3, s2, 1
    s_lshl_b32 s3, s3, 5
    s_lshr_b32 s4, s2, 3
    s_add_u32 s3, s3, s4
    s_cmp_ge_u32 s4, 32
    s_cselect_b32 s3, 63, s3
    s_cmp_ge_u32 s3, 63
    s_cbranch_scc1 L_idle
    s_mul_i32 s40, s3, 37
    s_lshr_b32 s40, s40, 8
    s_mul_i32 s6, s40, 7
    s_sub_u32 s37, s3, s6
    s_bfe_u32 s6, s2, 0x20001
    s_mul_i32 s6, s6, 9
    s_add_u32 s36, s6, s40
    s_mov_b32 s23, 0x00020000
    v_and_b32 v2, 31, v0
    v_bfe_u32 v3, v0, 5, 1
L_prod:
    s_setprio 1
    s_sub_u32 s43, s42, 4
    s_mov_b32 s22, 9437184
    s_lshl_b32 s5, s37, 2
    s_lshl_b32 s5, 15, s5
    s_sub_u32 s41, 0x76543210, s5
    v_mul_u32_u24 v4, 147456, v3
    v_lshl_add_u32 v8, v2, 4, v4
    s_lshl_b32 s44, s36, 9
    s_mul_i32 s5, s43, 294912
    s_add_u32 s44, s44, s5
    s_movk_i32 s7, 18432
    s_and_b32 s5, s41, 7
    s_mul_i32 s5, s5, 1179648
    s_add_u32 s46, s44, s5
    s_waitcnt lgkmcnt(0)
    buffer_load_dwordx4 v[64:67], v8, s[20:23], s46 offen
    v_add_u32 v9, s7, v8
    buffer_load_dwordx4 v[68:71], v9, s[20:23], s46 offen
    s_mov_b32 s27, s23
    s_mov_b32 s26, 36864
    v_lshlrev_b32 v28, 3, v2
    v_lshl_add_u32 v28, v3, 2, v28
    s_mul_i32 s5, s43, 9216
    s_lshl_b32 s6, s36, 8
    s_add_u32 s5, s5, s6
    buffer_load_dword v7, v28, s[24:27], s5 offen
    v_add_u32 v10, s7, v9
    buffer_load_dwordx4 v[72:75], v10, s[20:23], s46 offen
    v_add_u32 v11, s7, v10
    buffer_load_dwordx4 v[76:79], v11, s[20:23], s46 offen
    v_add_u32 v12, s7, v11
    buffer_load_dwordx4 v[80:83], v12, s[20:23], s46 offen
    v_add_u32 v13, s7, v12
    buffer_load_dwordx4 v[84:87], v13, s[20:23], s46 offen
    v_add_u32 v14, s7, v13
    buffer_load_dwordx4 v[88:91], v14, s[20:23], s46 offen
    v_add_u32 v15, s7, v14
    buffer_load_dwordx4 v[92:95], v15, s[20:23], s46 offen
    s_mov_b32 s19, s23
    s_mov_b32 s18, 2097152
    v_and_b32 v1, 63, v0
    v_lshrrev_b32 v4, 3, v1
    v_and_b32 v5, 7, v1
    v_lshrrev_b32 v6, 1, v4
    v_xor_b32 v5, v5, v6
    v_lshlrev_b32 v5, 4, v5
    v_lshl_add_u32 v16, v4, 10, v5
    s_min_u32 s5, s37, 2
    s_mul_i32 s38, s37, 18
    s_add_u32 s38, s38, s5
    s_lshl_b32 s45, s38, 14
    s_mul_i32 s9, s43, 5120
    s_lshl_b32 s5, s9, 3
    s_add_u32 s45, s45, s5
    s_and_b32 s5, s41, 7
    s_lshl_b32 s5, s5, 7
    s_add_u32 s47, s45, s5
    v_mov_b32 v30, v16
    v_add_u32 v31, 7168, v16
    v_xor_b32 v31, 64, v31
    s_and_b32 s5, s43, 1
    s_lshl_b32 s5, s5, 6
    v_xor_b32 v16, s5, v16
    s_add_u32 m0, s9, 122880
    s_nop 0
    buffer_load_dwordx4 v16, s[16:19], s47 offen offset:0 lds
    v_add_u32 v17, 7168, v16
    v_xor_b32 v17, 64, v17
    v_add_u32 v18, 14336, v16
    v_add_u32 v19, 21504, v16
    v_xor_b32 v19, 64, v19
    v_add_u32 v20, 32768, v16
    v_lshrrev_b32 v4, 3, v2
    v_lshlrev_b32 v4, 12, v4
    v_and_b32 v5, 7, v2
    v_lshl_add_u32 v4, v5, 4, v4
    v_lshl_add_u32 v4, v3, 8, v4
    s_lshr_b32 s5, s43, 1
    s_lshl_b32 s5, s5, 11
    s_and_b32 s6, s43, 1
    s_lshl_b32 s6, s6, 9
    s_add_u32 s5, s5, s6
    v_add_u32 v22, s5, v4
    v_lshlrev_b32 v29, 2, v2
    s_lshl_b32 s5, s43, 3
    s_lshr_b32 s5, s41, s5
    s_and_b32 s6, s5, 7
    s_lshl_b32 s6, s6, 7
    s_bfe_u32 s5, s5, 0x30004
    s_lshl_b32 s5, s5, 7
    s_add_u32 s7, s38, 10
    s_lshl_b32 s7, s7, 14
    s_add_u32 s52, s7, s6
    s_add_u32 s53, s7, s5
    s_lshl_b32 s51, s43, 12
    s_mov_b32 s10, 0
    s_mov_b32 s11, 0x40600000
    s_cmp_lt_u32 s37, 2
    s_cselect_b32 s58, 9, 8
    s_lshl_b32 s58, s58, 14
    s_lshl_b32 s5, s40, 2
    s_lshr_b32 s5, 0x40404040, s5
    s_and_b32 s5, s5, 15
    s_lshl_b32 s56, s5, 14
    s_bfe_u32 s5, s41, 0x30004
    s_lshl_b32 s6, s5, 7
    s_add_u32 s61, s45, s6
    s_mul_i32 s5, s5, 1179648
    s_add_u32 s12, s44, s5
    s_bfe_u32 s5, s41, 0x30008
    s_lshl_b32 s6, s5, 7
    s_add_u32 s96, s45, s6
    s_mul_i32 s5, s5, 1179648
    s_add_u32 s13, s44, s5
    s_bfe_u32 s5, s41, 0x3000c
    s_lshl_b32 s6, s5, 7
    s_add_u32 s97, s45, s6
    s_mul_i32 s5, s5, 1179648
    s_add_u32 s14, s44, s5
    s_bfe_u32 s5, s41, 0x30010
    s_lshl_b32 s6, s5, 7
    s_add_u32 s98, s45, s6
    s_mul_i32 s5, s5, 1179648
    s_add_u32 s15, s44, s5
    s_bfe_u32 s5, s41, 0x30014
    s_lshl_b32 s6, s5, 7
    s_add_u32 s99, s45, s6
    s_mul_i32 s5, s5, 1179648
    s_add_u32 s39, s44, s5
    s_bfe_u32 s5, s41, 0x30018
    s_lshl_b32 s6, s5, 7
    s_add_u32 s100, s45, s6
    s_mul_i32 s5, s5, 1179648
    s_add_u32 s48, s44, s5
    s_bfe_u32 s5, s41, 0x3001c
    s_lshl_b32 s6, s5, 7
    s_add_u32 s101, s45, s6
    s_mul_i32 s5, s5, 1179648
    s_add_u32 s60, s44, s5
    v_mov_b32 v24, v29
    v_mov_b32 v25, v29
    v_lshlrev_b32 v26, 2, v29
    v_add_u32 v26, 100352, v26
    s_bfe_u32 s5, s41, 0x20001
    v_lshl_add_u32 v23, s5, 9, v26
    s_lshl_b32 s5, s43, 9
    v_lshl_add_u32 v28, v28, 1, s5
    v_add_u32 v28, 100352, v28
    buffer_load_dwordx4 v17, s[16:19], s47 offen offset:1024 lds
    buffer_load_dwordx4 v18, s[16:19], s47 offen offset:2048 lds
    s_waitcnt vmcnt(9)
    v_lshlrev_b32 v6, 16, v7
    v_and_b32 v7, 0xffff0000, v7
    ds_write_b64 v28, v[6:7]
    buffer_load_dwordx4 v19, s[16:19], s47 offen offset:3072 lds
    s_add_u32 m0, s9, 126976
    s_nop 0
    buffer_load_dwordx4 v20, s[16:19], s47 offen offset:0 lds
    s_add_u32 m0, s9, 143360
    buffer_load_dwordx4 v[96:99], v8, s[20:23], s12 offen
    s_waitcnt lgkmcnt(0)
    s_barrier
    ds_read_b128 v[56:59], v23
    v_lshl_add_u64 v[64:65], v[68:69], 4, v[64:65]
    v_lshl_add_u64 v[66:67], v[70:71], 4, v[66:67]
    v_fma_f64 v[64:65], v[64:65], s[10:11], v[24:25]
    v_fma_f64 v[66:67], v[66:67], s[10:11], v[24:25]
    ds_read_b32 v32, v64
    ds_read_b32 v36, v65
    ds_read_b32 v40, v66
    ds_read_b32 v44, v67
    s_waitcnt vmcnt(10)
    v_lshl_add_u64 v[72:73], v[76:77], 4, v[72:73]
    v_lshl_add_u64 v[74:75], v[78:79], 4, v[74:75]
    v_fma_f64 v[72:73], v[72:73], s[10:11], v[24:25]
    v_fma_f64 v[74:75], v[74:75], s[10:11], v[24:25]
    ds_read_b32 v33, v72
    ds_read_b32 v37, v73
    ds_read_b32 v41, v74
    ds_read_b32 v45, v75
    s_waitcnt lgkmcnt(4)
    v_fma_mix_f32 v48, v32, v56, 0 op_sel_hi:[1,0,0]
    v_fma_mix_f32 v49, v32, v56, 0 op_sel:[1,0,0] op_sel_hi:[1,0,0]
    v_fma_mix_f32 v50, v36, v57, 0 op_sel_hi:[1,0,0]
    v_fma_mix_f32 v51, v36, v57, 0 op_sel:[1,0,0] op_sel_hi:[1,0,0]
    v_cvt_pk_bf16_f32 v32, v48, v49
    v_cvt_pk_bf16_f32 v36, v50, v51
    v_fma_mix_f32 v52, v40, v58, 0 op_sel_hi:[1,0,0]
    v_fma_mix_f32 v53, v40, v58, 0 op_sel:[1,0,0] op_sel_hi:[1,0,0]
    v_fma_mix_f32 v54, v44, v59, 0 op_sel_hi:[1,0,0]
    v_fma_mix_f32 v55, v44, v59, 0 op_sel:[1,0,0] op_sel_hi:[1,0,0]
    v_cvt_pk_bf16_f32 v40, v52, v53
    v_cvt_pk_bf16_f32 v44, v54, v55
    s_waitcnt vmcnt(8)
    v_lshl_add_u64 v[80:81], v[84:85], 4, v[80:81]
    v_lshl_add_u64 v[82:83], v[86:87], 4, v[82:83]
    v_fma_f64 v[80:81], v[80:81], s[10:11], v[24:25]
    v_fma_f64 v[82:83], v[82:83], s[10:11], v[24:25]
    buffer_load_dwordx4 v[100:103], v9, s[20:23], s12 offen
    ds_read_b32 v34, v80
    ds_read_b32 v38, v81
    ds_read_b32 v42, v82
    ds_read_b32 v46, v83
    s_waitcnt lgkmcnt(4)
    v_fma_mix_f32 v48, v33, v56, 0 op_sel_hi:[1,0,0]
    v_fma_mix_f32 v49, v33, v56, 0 op_sel:[1,0,0] op_sel_hi:[1,0,0]
    v_fma_mix_f32 v50, v37, v57, 0 op_sel_hi:[1,0,0]
    v_fma_mix_f32 v51, v37, v57, 0 op_sel:[1,0,0] op_sel_hi:[1,0,0]
    v_cvt_pk_bf16_f32 v33, v48, v49
    v_cvt_pk_bf16_f32 v37, v50, v51
    buffer_load_dwordx4 v[104:107], v10, s[20:23], s12 offen
    v_fma_mix_f32 v52, v41, v58, 0 op_sel_hi:[1,0,0]
    v_fma_mix_f32 v53, v41, v58, 0 op_sel:[1,0,0] op_sel_hi:[1,0,0]
    v_fma_mix_f32 v54, v45, v59, 0 op_sel_hi:[1,0,0]
    v_fma_mix_f32 v55, v45, v59, 0 op_sel:[1,0,0] op_sel_hi:[1,0,0]
    v_cvt_pk_bf16_f32 v41, v52, v53
    v_cvt_pk_bf16_f32 v45, v54, v55
    s_waitcnt vmcnt(8)
    v_lshl_add_u64 v[88:89], v[92:93], 4, v[88:89]
    v_lshl_add_u64 v[90:91], v[94:95], 4, v[90:91]
    v_fma_f64 v[88:89], v[88:89], s[10:11], v[24:25]
    v_fma_f64 v[90:91], v[90:91], s[10:11], v[24:25]
    buffer_load_dwordx4 v[108:111], v11, s[20:23], s12 offen
    ds_read_b32 v35, v88
    ds_read_b32 v39, v89
    ds_read_b32 v43, v90
    ds_read_b32 v47, v91
    buffer_load_dwordx4 v[112:115], v12, s[20:23], s12 offen
    s_waitcnt lgkmcnt(4)
    v_fma_mix_f32 v48, v34, v56, 0 op_sel_hi:[1,0,0]
    v_fma_mix_f32 v49, v34, v56, 0 op_sel:[1,0,0] op_sel_hi:[1,0,0]
    v_fma_mix_f32 v50, v38, v57, 0 op_sel_hi:[1,0,0]
    v_fma_mix_f32 v51, v38, v57, 0 op_sel:[1,0,0] op_sel_hi:[1,0,0]
    v_cvt_pk_bf16_f32 v34, v48, v49
    v_cvt_pk_bf16_f32 v38, v50, v51
    v_fma_mix_f32 v52, v42, v58, 0 op_sel_hi:[1,0,0]
    v_fma_mix_f32 v53, v42, v58, 0 op_sel:[1,0,0] op_sel_hi:[1,0,0]
    v_fma_mix_f32 v54, v46, v59, 0 op_sel_hi:[1,0,0]
    v_fma_mix_f32 v55, v46, v59, 0 op_sel:[1,0,0] op_sel_hi:[1,0,0]
    v_cvt_pk_bf16_f32 v42, v52, v53
    v_cvt_pk_bf16_f32 v46, v54, v55
    buffer_load_dwordx4 v[116:119], v13, s[20:23], s12 offen
    s_bfe_u32 s5, s41, 0x20005
    v_lshl_add_u32 v23, s5, 9, v26
    ds_read_b128 v[60:63], v23
    s_waitcnt lgkmcnt(1)
    v_fma_mix_f32 v48, v35, v56, 0 op_sel_hi:[1,0,0]
    v_fma_mix_f32 v49, v35, v56, 0 op_sel:[1,0,0] op_sel_hi:[1,0,0]
    v_fma_mix_f32 v50, v39, v57, 0 op_sel_hi:[1,0,0]
    v_fma_mix_f32 v51, v39, v57, 0 op_sel:[1,0,0] op_sel_hi:[1,0,0]
    v_cvt_pk_bf16_f32 v35, v48, v49
    v_cvt_pk_bf16_f32 v39, v50, v51
    ds_write_b128 v22, v[32:35] offset:32768
    buffer_load_dwordx4 v[120:123], v14, s[20:23], s12 offen
    ds_write_b128 v22, v[36:39] offset:33792
    buffer_load_dwordx4 v[124:127], v15, s[20:23], s12 offen
    v_fma_mix_f32 v52, v43, v58, 0 op_sel_hi:[1,0,0]
    v_fma_mix_f32 v53, v43, v58, 0 op_sel:[1,0,0] op_sel_hi:[1,0,0]
    v_fma_mix_f32 v54, v47, v59, 0 op_sel_hi:[1,0,0]
    v_fma_mix_f32 v55, v47, v59, 0 op_sel:[1,0,0] op_sel_hi:[1,0,0]
    v_cvt_pk_bf16_f32 v43, v52, v53
    v_cvt_pk_bf16_f32 v47, v54, v55
    buffer_load_dwordx4 v16, s[16:19], s61 offen offset:0 lds
    ds_write_b128 v22, v[40:43] offset:32896
    buffer_load_dwordx4 v17, s[16:19], s61 offen offset:1024 lds
    ds_write_b128 v22, v[44:47] offset:33920
    buffer_load_dwordx4 v18, s[16:19], s61 offen offset:2048 lds
    s_waitcnt vmcnt(11)
    s_waitcnt lgkmcnt(0)
    s_barrier
    s_setprio 0
    s_waitcnt vmcnt(9)
    v_lshl_add_u64 v[96:97], v[100:101], 4, v[96:97]
    v_lshl_add_u64 v[98:99], v[102:103], 4, v[98:99]
    v_fma_f64 v[96:97], v[96:97], s[10:11], v[24:25]
    v_fma_f64 v[98:99], v[98:99], s[10:11], v[24:25]
    ds_read_b32 v32, v96
    ds_read_b32 v36, v97
    ds_read_b32 v40, v98
    ds_read_b32 v44, v99
    buffer_load_dwordx4 v19, s[16:19], s61 offen offset:3072 lds
    s_add_u32 m0, s9, 147456
    s_waitcnt vmcnt(8)
    v_lshl_add_u64 v[104:105], v[108:109], 4, v[104:105]
    v_lshl_add_u64 v[106:107], v[110:111], 4, v[106:107]
    v_fma_f64 v[104:105], v[104:105], s[10:11], v[24:25]
    v_fma_f64 v[106:107], v[106:107], s[10:11], v[24:25]
    ds_read_b32 v33, v104
    ds_read_b32 v37, v105
    ds_read_b32 v41, v106
    ds_read_b32 v45, v107
    buffer_load_dwordx4 v20, s[16:19], s61 offen offset:0 lds
    s_add_u32 m0, s9, 102400
    s_waitcnt lgkmcnt(4)
    v_fma_mix_f32 v48, v32, v60, 0 op_sel_hi:[1,0,0]
    v_fma_mix_f32 v49, v32, v60, 0 op_sel:[1,0,0] op_sel_hi:[1,0,0]
    v_fma_mix_f32 v50, v36, v61, 0 op_sel_hi:[1,0,0]
    v_fma_mix_f32 v51, v36, v61, 0 op_sel:[1,0,0] op_sel_hi:[1,0,0]
    v_cvt_pk_bf16_f32 v32, v48, v49
    v_cvt_pk_bf16_f32 v36, v50, v51
    buffer_load_dwordx4 v[64:67], v8, s[20:23], s13 offen
    v_fma_mix_f32 v52, v40, v62, 0 op_sel_hi:[1,0,0]
    v_fma_mix_f32 v53, v40, v62, 0 op_sel:[1,0,0] op_sel_hi:[1,0,0]
    v_fma_mix_f32 v54, v44, v63, 0 op_sel_hi:[1,0,0]
    v_fma_mix_f32 v55, v44, v63, 0 op_sel:[1,0,0] op_sel_hi:[1,0,0]
    v_cvt_pk_bf16_f32 v40, v52, v53
    v_cvt_pk_bf16_f32 v44, v54, v55
    s_waitcnt vmcnt(8)
    v_lshl_add_u64 v[112:113], v[116:117], 4, v[112:113]
    v_lshl_add_u64 v[114:115], v[118:119], 4, v[114:115]
    v_fma_f64 v[112:113], v[112:113], s[10:11], v[24:25]
    v_fma_f64 v[114:115], v[114:115], s[10:11], v[24:25]
    buffer_load_dwordx4 v[68:71], v9, s[20:23], s13 offen
    ds_read_b32 v34, v112
    ds_read_b32 v38, v113
    ds_read_b32 v42, v114
    ds_read_b32 v46, v115
    s_waitcnt lgkmcnt(4)
    v_fma_mix_f32 v48, v33, v60, 0 op_sel_hi:[1,0,0]
    v_fma_mix_f32 v49, v33, v60, 0 op_sel:[1,0,0] op_sel_hi:[1,0,0]
    v_fma_mix_f32 v50, v37, v61, 0 op_sel_hi:[1,0,0]
    v_fma_mix_f32 v51, v37, v61, 0 op_sel:[1,0,0] op_sel_hi:[1,0,0]
    v_cvt_pk_bf16_f32 v33, v48, v49
    v_cvt_pk_bf16_f32 v37, v50, v51
    buffer_load_dwordx4 v[72:75], v10, s[20:23], s13 offen
    v_fma_mix_f32 v52, v41, v62, 0 op_sel_hi:[1,0,0]
    v_fma_mix_f32 v53, v41, v62, 0 op_sel:[1,0,0] op_sel_hi:[1,0,0]
    v_fma_mix_f32 v54, v45, v63, 0 op_sel_hi:[1,0,0]
    v_fma_mix_f32 v55, v45, v63, 0 op_sel:[1,0,0] op_sel_hi:[1,0,0]
    v_cvt_pk_bf16_f32 v41, v52, v53
    v_cvt_pk_bf16_f32 v45, v54, v55
    s_waitcnt vmcnt(8)
    v_lshl_add_u64 v[120:121], v[124:125], 4, v[120:121]
    v_lshl_add_u64 v[122:123], v[126:127], 4, v[122:123]
    v_fma_f64 v[120:121], v[120:121], s[10:11], v[24:25]
    v_fma_f64 v[122:123], v[122:123], s[10:11], v[24:25]
    buffer_load_dwordx4 v[76:79], v11, s[20:23], s13 offen
    ds_read_b32 v35, v120
    ds_read_b32 v39, v121
    ds_read_b32 v43, v122
    ds_read_b32 v47, v123
    s_waitcnt lgkmcnt(4)
    v_fma_mix_f32 v48, v34, v60, 0 op_sel_hi:[1,0,0]
    v_fma_mix_f32 v49, v34, v60, 0 op_sel:[1,0,0] op_sel_hi:[1,0,0]
    v_fma_mix_f32 v50, v38, v61, 0 op_sel_hi:[1,0,0]
    v_fma_mix_f32 v51, v38, v61, 0 op_sel:[1,0,0] op_sel_hi:[1,0,0]
    v_cvt_pk_bf16_f32 v34, v48, v49
    v_cvt_pk_bf16_f32 v38, v50, v51
    buffer_load_dwordx4 v[80:83], v12, s[20:23], s13 offen
    v_fma_mix_f32 v52, v42, v62, 0 op_sel_hi:[1,0,0]
    v_fma_mix_f32 v53, v42, v62, 0 op_sel:[1,0,0] op_sel_hi:[1,0,0]
    v_fma_mix_f32 v54, v46, v63, 0 op_sel_hi:[1,0,0]
    v_fma_mix_f32 v55, v46, v63, 0 op_sel:[1,0,0] op_sel_hi:[1,0,0]
    v_cvt_pk_bf16_f32 v42, v52, v53
    v_cvt_pk_bf16_f32 v46, v54, v55
    buffer_load_dwordx4 v[84:87], v13, s[20:23], s13 offen
    s_bfe_u32 s5, s41, 0x20009
    v_lshl_add_u32 v23, s5, 9, v26
    ds_read_b128 v[56:59], v23
    s_waitcnt lgkmcnt(1)
    v_fma_mix_f32 v48, v35, v60, 0 op_sel_hi:[1,0,0]
    v_fma_mix_f32 v49, v35, v60, 0 op_sel:[1,0,0] op_sel_hi:[1,0,0]
    v_fma_mix_f32 v50, v39, v61, 0 op_sel_hi:[1,0,0]
    v_fma_mix_f32 v51, v39, v61, 0 op_sel:[1,0,0] op_sel_hi:[1,0,0]
    v_cvt_pk_bf16_f32 v35, v48, v49
    v_cvt_pk_bf16_f32 v39, v50, v51
    ds_write_b128 v22, v[32:35] offset:49152
    buffer_load_dwordx4 v[88:91], v14, s[20:23], s13 offen
    ds_write_b128 v22, v[36:39] offset:50176
    buffer_load_dwordx4 v[92:95], v15, s[20:23], s13 offen
    v_fma_mix_f32 v52, v43, v62, 0 op_sel_hi:[1,0,0]
    v_fma_mix_f32 v53, v43, v62, 0 op_sel:[1,0,0] op_sel_hi:[1,0,0]
    v_fma_mix_f32 v54, v47, v63, 0 op_sel_hi:[1,0,0]
    v_fma_mix_f32 v55, v47, v63, 0 op_sel:[1,0,0] op_sel_hi:[1,0,0]
    v_cvt_pk_bf16_f32 v43, v52, v53
    v_cvt_pk_bf16_f32 v47, v54, v55
    buffer_load_dwordx4 v16, s[16:19], s96 offen offset:0 lds
    ds_write_b128 v22, v[40:43] offset:49280
    buffer_load_dwordx4 v17, s[16:19], s96 offen offset:1024 lds
    ds_write_b128 v22, v[44:47] offset:50304
    buffer_load_dwordx4 v18, s[16:19], s96 offen offset:2048 lds
    s_waitcnt vmcnt(11)
    s_branch L_pg0
.p2align 12
L_stub0:
    s_branch L_warmed
L_pg0:
    s_waitcnt lgkmcnt(0)
    s_barrier
    s_waitcnt vmcnt(9)
    v_lshl_add_u64 v[64:65], v[68:69], 4, v[64:65]
    v_lshl_add_u64 v[66:67], v[70:71], 4, v[66:67]
    v_fma_f64 v[64:65], v[64:65], s[10:11], v[24:25]
    v_fma_f64 v[66:67], v[66:67], s[10:11], v[24:25]
    ds_read_b32 v32, v64
    ds_read_b32 v36, v65
    ds_read_b32 v40, v66
    ds_read_b32 v44, v67
    buffer_load_dwordx4 v19, s[16:19], s96 offen offset:3072 lds
    s_add_u32 m0, s9, 106496
    s_waitcnt vmcnt(8)
    v_lshl_add_u64 v[72:73], v[76:77], 4, v[72:73]
    v_lshl_add_u64 v[74:75], v[78:79], 4, v[74:75]
    v_fma_f64 v[72:73], v[72:73], s[10:11], v[24:25]
    v_fma_f64 v[74:75], v[74:75], s[10:11], v[24:25]
    ds_read_b32 v33, v72
    ds_read_b32 v37, v73
    ds_read_b32 v41, v74
    ds_read_b32 v45, v75
    buffer_load_dwordx4 v20, s[16:19], s96 offen offset:0 lds
    s_add_u32 m0, s9, 122880
    s_waitcnt lgkmcnt(4)
    v_fma_mix_f32 v48, v32, v56, 0 op_sel_hi:[1,0,0]
    v_fma_mix_f32 v49, v32, v56, 0 op_sel:[1,0,0] op_sel_hi:[1,0,0]
    v_fma_mix_f32 v50, v36, v57, 0 op_sel_hi:[1,0,0]
    v_fma_mix_f32 v51, v36, v57, 0 op_sel:[1,0,0] op_sel_hi:[1,0,0]
    v_cvt_pk_bf16_f32 v32, v48, v49
    v_cvt_pk_bf16_f32 v36, v50, v51
    buffer_load_dwordx4 v[96:99], v8, s[20:23], s14 offen
    v_fma_mix_f32 v52, v40, v58, 0 op_sel_hi:[1,0,0]
    v_fma_mix_f32 v53, v40, v58, 0 op_sel:[1,0,0] op_sel_hi:[1,0,0]
    v_fma_mix_f32 v54, v44, v59, 0 op_sel_hi:[1,0,0]
    v_fma_mix_f32 v55, v44, v59, 0 op_sel:[1,0,0] op_sel_hi:[1,0,0]
    v_cvt_pk_bf16_f32 v40, v52, v53
    v_cvt_pk_bf16_f32 v44, v54, v55
    s_waitcnt vmcnt(8)
    v_lshl_add_u64 v[80:81], v[84:85], 4, v[80:81]
    v_lshl_add_u64 v[82:83], v[86:87], 4, v[82:83]
    v_fma_f64 v[80:81], v[80:81], s[10:11], v[24:25]
    v_fma_f64 v[82:83], v[82:83], s[10:11], v[24:25]
    buffer_load_dwordx4 v[100:103], v9, s[20:23], s14 offen
    ds_read_b32 v34, v80
    ds_read_b32 v38, v81
    ds_read_b32 v42, v82
    ds_read_b32 v46, v83
    s_waitcnt lgkmcnt(4)
    v_fma_mix_f32 v48, v33, v56, 0 op_sel_hi:[1,0,0]
    v_fma_mix_f32 v49, v33, v56, 0 op_sel:[1,0,0] op_sel_hi:[1,0,0]
    v_fma_mix_f32 v50, v37, v57, 0 op_sel_hi:[1,0,0]
    v_fma_mix_f32 v51, v37, v57, 0 op_sel:[1,0,0] op_sel_hi:[1,0,0]
    v_cvt_pk_bf16_f32 v33, v48, v49
    v_cvt_pk_bf16_f32 v37, v50, v51
    buffer_load_dwordx4 v[104:107], v10, s[20:23], s14 offen
    v_fma_mix_f32 v52, v41, v58, 0 op_sel_hi:[1,0,0]
    v_fma_mix_f32 v53, v41, v58, 0 op_sel:[1,0,0] op_sel_hi:[1,0,0]
    v_fma_mix_f32 v54, v45, v59, 0 op_sel_hi:[1,0,0]
    v_fma_mix_f32 v55, v45, v59, 0 op_sel:[1,0,0] op_sel_hi:[1,0,0]
    v_cvt_pk_bf16_f32 v41, v52, v53
    v_cvt_pk_bf16_f32 v45, v54, v55
    s_waitcnt vmcnt(8)
    v_lshl_add_u64 v[88:89], v[92:93], 4, v[88:89]
    v_lshl_add_u64 v[90:91], v[94:95], 4, v[90:91]
    v_fma_f64 v[88:89], v[88:89], s[10:11], v[24:25]
    v_fma_f64 v[90:91], v[90:91], s[10:11], v[24:25]
    buffer_load_dwordx4 v[108:111], v11, s[20:23], s14 offen
    ds_read_b32 v35, v88
    ds_read_b32 v39, v89
    ds_read_b32 v43, v90
    ds_read_b32 v47, v91
    s_waitcnt lgkmcnt(4)
    v_fma_mix_f32 v48, v34, v56, 0 op_sel_hi:[1,0,0]
    v_fma_mix_f32 v49, v34, v56, 0 op_sel:[1,0,0] op_sel_hi:[1,0,0]
    v_fma_mix_f32 v50, v38, v57, 0 op_sel_hi:[1,0,0]
    v_fma_mix_f32 v51, v38, v57, 0 op_sel:[1,0,0] op_sel_hi:[1,0,0]
    v_cvt_pk_bf16_f32 v34, v48, v49
    v_cvt_pk_bf16_f32 v38, v50, v51
    buffer_load_dwordx4 v[112:115], v12, s[20:23], s14 offen
    v_fma_mix_f32 v52, v42, v58, 0 op_sel_hi:[1,0,0]
    v_fma_mix_f32 v53, v42, v58, 0 op_sel:[1,0,0] op_sel_hi:[1,0,0]
    v_fma_mix_f32 v54, v46, v59, 0 op_sel_hi:[1,0,0]
    v_fma_mix_f32 v55, v46, v59, 0 op_sel:[1,0,0] op_sel_hi:[1,0,0]
    v_cvt_pk_bf16_f32 v42, v52, v53
    v_cvt_pk_bf16_f32 v46, v54, v55
    buffer_load_dwordx4 v[116:119], v13, s[20:23], s14 offen
    s_bfe_u32 s5, s41, 0x2000d
    v_lshl_add_u32 v23, s5, 9, v26
    ds_read_b128 v[60:63], v23
    s_waitcnt lgkmcnt(1)
    v_fma_mix_f32 v48, v35, v56, 0 op_sel_hi:[1,0,0]
    v_fma_mix_f32 v49, v35, v56, 0 op_sel:[1,0,0] op_sel_hi:[1,0,0]
    v_fma_mix_f32 v50, v39, v57, 0 op_sel_hi:[1,0,0]
    v_fma_mix_f32 v51, v39, v57, 0 op_sel:[1,0,0] op_sel_hi:[1,0,0]
    v_cvt_pk_bf16_f32 v35, v48, v49
    v_cvt_pk_bf16_f32 v39, v50, v51
    ds_write_b128 v22, v[32:35] offset:32768
    buffer_load_dwordx4 v[120:123], v14, s[20:23], s14 offen
    ds_write_b128 v22, v[36:39] offset:33792
    buffer_load_dwordx4 v[124:127], v15, s[20:23], s14 offen
    v_fma_mix_f32 v52, v43, v58, 0 op_sel_hi:[1,0,0]
    v_fma_mix_f32 v53, v43, v58, 0 op_sel:[1,0,0] op_sel_hi:[1,0,0]
    v_fma_mix_f32 v54, v47, v59, 0 op_sel_hi:[1,0,0]
    v_fma_mix_f32 v55, v47, v59, 0 op_sel:[1,0,0] op_sel_hi:[1,0,0]
    v_cvt_pk_bf16_f32 v43, v52, v53
    v_cvt_pk_bf16_f32 v47, v54, v55
    buffer_load_dwordx4 v16, s[16:19], s97 offen offset:0 lds
    ds_write_b128 v22, v[40:43] offset:32896
    buffer_load_dwordx4 v17, s[16:19], s97 offen offset:1024 lds
    ds_write_b128 v22, v[44:47] offset:33920
    buffer_load_dwordx4 v18, s[16:19], s97 offen offset:2048 lds
    s_waitcnt vmcnt(11)
    s_waitcnt lgkmcnt(0)
    s_barrier
    s_setprio 1
    s_waitcnt vmcnt(9)
    v_lshl_add_u64 v[96:97], v[100:101], 4, v[96:97]
    v_lshl_add_u64 v[98:99], v[102:103], 4, v[98:99]
    v_fma_f64 v[96:97], v[96:97], s[10:11], v[24:25]
    v_fma_f64 v[98:99], v[98:99], s[10:11], v[24:25]
    ds_read_b32 v32, v96
    ds_read_b32 v36, v97
    ds_read_b32 v40, v98
    ds_read_b32 v44, v99
    buffer_load_dwordx4 v19, s[16:19], s97 offen offset:3072 lds
    s_add_u32 m0, s9, 126976
    s_waitcnt vmcnt(8)
    v_lshl_add_u64 v[104:105], v[108:109], 4, v[104:105]
    v_lshl_add_u64 v[106:107], v[110:111], 4, v[106:107]
    v_fma_f64 v[104:105], v[104:105], s[10:11], v[24:25]
    v_fma_f64 v[106:107], v[106:107], s[10:11], v[24:25]
    ds_read_b32 v33, v104
    ds_read_b32 v37, v105
    ds_read_b32 v41, v106
    ds_read_b32 v45, v107
    buffer_load_dwordx4 v20, s[16:19], s97 offen offset:0 lds
    s_add_u32 m0, s9, 143360
    s_waitcnt lgkmcnt(4)
    v_fma_mix_f32 v48, v32, v60, 0 op_sel_hi:[1,0,0]
    v_fma_mix_f32 v49, v32, v60, 0 op_sel:[1,0,0] op_sel_hi:[1,0,0]
    v_fma_mix_f32 v50, v36, v61, 0 op_sel_hi:[1,0,0]
    v_fma_mix_f32 v51, v36, v61, 0 op_sel:[1,0,0] op_sel_hi:[1,0,0]
    v_cvt_pk_bf16_f32 v32, v48, v49
    v_cvt_pk_bf16_f32 v36, v50, v51
    buffer_load_dwordx4 v[64:67], v8, s[20:23], s15 offen
    v_fma_mix_f32 v52, v40, v62, 0 op_sel_hi:[1,0,0]
    v_fma_mix_f32 v53, v40, v62, 0 op_sel:[1,0,0] op_sel_hi:[1,0,0]
    v_fma_mix_f32 v54, v44, v63, 0 op_sel_hi:[1,0,0]
    v_fma_mix_f32 v55, v44, v63, 0 op_sel:[1,0,0] op_sel_hi:[1,0,0]
    v_cvt_pk_bf16_f32 v40, v52, v53
    v_cvt_pk_bf16_f32 v44, v54, v55
    s_waitcnt vmcnt(8)
    v_lshl_add_u64 v[112:113], v[116:117], 4, v[112:113]
    v_lshl_add_u64 v[114:115], v[118:119], 4, v[114:115]
    v_fma_f64 v[112:113], v[112:113], s[10:11], v[24:25]
    v_fma_f64 v[114:115], v[114:115], s[10:11], v[24:25]
    buffer_load_dwordx4 v[68:71], v9, s[20:23], s15 offen
    ds_read_b32 v34, v112
    ds_read_b32 v38, v113
    ds_read_b32 v42, v114
    ds_read_b32 v46, v115
    s_waitcnt lgkmcnt(4)
    v_fma_mix_f32 v48, v33, v60, 0 op_sel_hi:[1,0,0]
    v_fma_mix_f32 v49, v33, v60, 0 op_sel:[1,0,0] op_sel_hi:[1,0,0]
    v_fma_mix_f32 v50, v37, v61, 0 op_sel_hi:[1,0,0]
    v_fma_mix_f32 v51, v37, v61, 0 op_sel:[1,0,0] op_sel_hi:[1,0,0]
    v_cvt_pk_bf16_f32 v33, v48, v49
    v_cvt_pk_bf16_f32 v37, v50, v51
    buffer_load_dwordx4 v[72:75], v10, s[20:23], s15 offen
    v_fma_mix_f32 v52, v41, v62, 0 op_sel_hi:[1,0,0]
    v_fma_mix_f32 v53, v41, v62, 0 op_sel:[1,0,0] op_sel_hi:[1,0,0]
    v_fma_mix_f32 v54, v45, v63, 0 op_sel_hi:[1,0,0]
    v_fma_mix_f32 v55, v45, v63, 0 op_sel:[1,0,0] op_sel_hi:[1,0,0]
    v_cvt_pk_bf16_f32 v41, v52, v53
    v_cvt_pk_bf16_f32 v45, v54, v55
    buffer_load_dwordx4 v[76:79], v11, s[20:23], s15 offen
    s_waitcnt vmcnt(9)
    v_lshl_add_u64 v[120:121], v[124:125], 4, v[120:121]
    v_lshl_add_u64 v[122:123], v[126:127], 4, v[122:123]
    v_fma_f64 v[120:121], v[120:121], s[10:11], v[24:25]
    v_fma_f64 v[122:123], v[122:123], s[10:11], v[24:25]
    ds_read_b32 v35, v120
    ds_read_b32 v39, v121
    ds_read_b32 v43, v122
    ds_read_b32 v47, v123
    buffer_load_dwordx4 v[80:83], v12, s[20:23], s15 offen
    s_waitcnt lgkmcnt(4)
    v_fma_mix_f32 v48, v34, v60, 0 op_sel_hi:[1,0,0]
    v_fma_mix_f32 v49, v34, v60, 0 op_sel:[1,0,0] op_sel_hi:[1,0,0]
    v_fma_mix_f32 v50, v38, v61, 0 op_sel_hi:[1,0,0]
    v_fma_mix_f32 v51, v38, v61, 0 op_sel:[1,0,0] op_sel_hi:[1,0,0]
    v_cvt_pk_bf16_f32 v34, v48, v49
    v_cvt_pk_bf16_f32 v38, v50, v51
    v_fma_mix_f32 v52, v42, v62, 0 op_sel_hi:[1,0,0]
    v_fma_mix_f32 v53, v42, v62, 0 op_sel:[1,0,0] op_sel_hi:[1,0,0]
    v_fma_mix_f32 v54, v46, v63, 0 op_sel_hi:[1,0,0]
    v_fma_mix_f32 v55, v46, v63, 0 op_sel:[1,0,0] op_sel_hi:[1,0,0]
    v_cvt_pk_bf16_f32 v42, v52, v53
    v_cvt_pk_bf16_f32 v46, v54, v55
    buffer_load_dwordx4 v[84:87], v13, s[20:23], s15 offen
    s_bfe_u32 s5, s41, 0x20011
    v_lshl_add_u32 v23, s5, 9, v26
    ds_read_b128 v[56:59], v23
    s_waitcnt lgkmcnt(1)
    v_fma_mix_f32 v48, v35, v60, 0 op_sel_hi:[1,0,0]
    v_fma_mix_f32 v49, v35, v60, 0 op_sel:[1,0,0] op_sel_hi:[1,0,0]
    v_fma_mix_f32 v50, v39, v61, 0 op_sel_hi:[1,0,0]
    v_fma_mix_f32 v51, v39, v61, 0 op_sel:[1,0,0] op_sel_hi:[1,0,0]
    v_cvt_pk_bf16_f32 v35, v48, v49
    v_cvt_pk_bf16_f32 v39, v50, v51
    buffer_load_dwordx4 v[88:91], v14, s[20:23], s15 offen
    ds_write_b128 v22, v[32:35] offset:49152
    buffer_load_dwordx4 v[92:95], v15, s[20:23], s15 offen
    ds_write_b128 v22, v[36:39] offset:50176
    buffer_load_dwordx4 v16, s[16:19], s98 offen offset:0 lds
    v_fma_mix_f32 v52, v43, v62, 0 op_sel_hi:[1,0,0]
    v_fma_mix_f32 v53, v43, v62, 0 op_sel:[1,0,0] op_sel_hi:[1,0,0]
    v_fma_mix_f32 v54, v47, v63, 0 op_sel_hi:[1,0,0]
    v_fma_mix_f32 v55, v47, v63, 0 op_sel:[1,0,0] op_sel_hi:[1,0,0]
    v_cvt_pk_bf16_f32 v43, v52, v53
    v_cvt_pk_bf16_f32 v47, v54, v55
    ds_write_b128 v22, v[40:43] offset:49280
    buffer_load_dwordx4 v17, s[16:19], s98 offen offset:1024 lds
    ds_write_b128 v22, v[44:47] offset:50304
    buffer_load_dwordx4 v18, s[16:19], s98 offen offset:2048 lds
    s_waitcnt vmcnt(9)
    v_lshl_add_u64 v[64:65], v[68:69], 4, v[64:65]
    v_lshl_add_u64 v[66:67], v[70:71], 4, v[66:67]
    v_fma_f64 v[64:65], v[64:65], s[10:11], v[24:25]
    v_fma_f64 v[66:67], v[66:67], s[10:11], v[24:25]
    ds_read_b32 v32, v64
    ds_read_b32 v36, v65
    ds_read_b32 v40, v66
    ds_read_b32 v44, v67
    buffer_load_dwordx4 v19, s[16:19], s98 offen offset:3072 lds
    s_add_u32 m0, s9, 147456
    s_waitcnt lgkmcnt(4)
    s_barrier
    buffer_load_dwordx4 v20, s[16:19], s98 offen offset:0 lds
    s_add_u32 m0, s9, 102400
    s_waitcnt vmcnt(9)
    v_lshl_add_u64 v[72:73], v[76:77], 4, v[72:73]
    v_lshl_add_u64 v[74:75], v[78:79], 4, v[74:75]
    v_fma_f64 v[72:73], v[72:73], s[10:11], v[24:25]
    v_fma_f64 v[74:75], v[74:75], s[10:11], v[24:25]
    ds_read_b32 v33, v72
    ds_read_b32 v37, v73
    ds_read_b32 v41, v74
    ds_read_b32 v45, v75
    buffer_load_dwordx4 v[96:99], v8, s[20:23], s39 offen
    s_waitcnt lgkmcnt(4)
    v_fma_mix_f32 v48, v32, v56, 0 op_sel_hi:[1,0,0]
    v_fma_mix_f32 v49, v32, v56, 0 op_sel:[1,0,0] op_sel_hi:[1,0,0]
    v_fma_mix_f32 v50, v36, v57, 0 op_sel_hi:[1,0,0]
    v_fma_mix_f32 v51, v36, v57, 0 op_sel:[1,0,0] op_sel_hi:[1,0,0]
    v_cvt_pk_bf16_f32 v32, v48, v49
    v_cvt_pk_bf16_f32 v36, v50, v51
    v_fma_mix_f32 v52, v40, v58, 0 op_sel_hi:[1,0,0]
    v_fma_mix_f32 v53, v40, v58, 0 op_sel:[1,0,0] op_sel_hi:[1,0,0]
    v_fma_mix_f32 v54, v44, v59, 0 op_sel_hi:[1,0,0]
    v_fma_mix_f32 v55, v44, v59, 0 op_sel:[1,0,0] op_sel_hi:[1,0,0]
    v_cvt_pk_bf16_f32 v40, v52, v53
    v_cvt_pk_bf16_f32 v44, v54, v55
    buffer_load_dwordx4 v[100:103], v9, s[20:23], s39 offen
    s_waitcnt vmcnt(9)
    v_lshl_add_u64 v[80:81], v[84:85], 4, v[80:81]
    v_lshl_add_u64 v[82:83], v[86:87], 4, v[82:83]
    v_fma_f64 v[80:81], v[80:81], s[10:11], v[24:25]
    v_fma_f64 v[82:83], v[82:83], s[10:11], v[24:25]
    ds_read_b32 v34, v80
    ds_read_b32 v38, v81
    ds_read_b32 v42, v82
    ds_read_b32 v46, v83
    buffer_load_dwordx4 v[104:107], v10, s[20:23], s39 offen
    s_waitcnt lgkmcnt(4)
    v_fma_mix_f32 v48, v33, v56, 0 op_sel_hi:[1,0,0]
    v_fma_mix_f32 v49, v33, v56, 0 op_sel:[1,0,0] op_sel_hi:[1,0,0]
    v_fma_mix_f32 v50, v37, v57, 0 op_sel_hi:[1,0,0]
    v_fma_mix_f32 v51, v37, v57, 0 op_sel:[1,0,0] op_sel_hi:[1,0,0]
    v_cvt_pk_bf16_f32 v33, v48, v49
    v_cvt_pk_bf16_f32 v37, v50, v51
    v_fma_mix_f32 v52, v41, v58, 0 op_sel_hi:[1,0,0]
    v_fma_mix_f32 v53, v41, v58, 0 op_sel:[1,0,0] op_sel_hi:[1,0,0]
    v_fma_mix_f32 v54, v45, v59, 0 op_sel_hi:[1,0,0]
    v_fma_mix_f32 v55, v45, v59, 0 op_sel:[1,0,0] op_sel_hi:[1,0,0]
    v_cvt_pk_bf16_f32 v41, v52, v53
    v_cvt_pk_bf16_f32 v45, v54, v55
    buffer_load_dwordx4 v[108:111], v11, s[20:23], s39 offen
    s_waitcnt vmcnt(9)
    v_lshl_add_u64 v[88:89], v[92:93], 4, v[88:89]
    v_lshl_add_u64 v[90:91], v[94:95], 4, v[90:91]
    v_fma_f64 v[88:89], v[88:89], s[10:11], v[24:25]
    v_fma_f64 v[90:91], v[90:91], s[10:11], v[24:25]
    ds_read_b32 v35, v88
    ds_read_b32 v39, v89
    ds_read_b32 v43, v90
    ds_read_b32 v47, v91
    buffer_load_dwordx4 v[112:115], v12, s[20:23], s39 offen
    s_waitcnt lgkmcnt(4)
    v_fma_mix_f32 v48, v34, v56, 0 op_sel_hi:[1,0,0]
    v_fma_mix_f32 v49, v34, v56, 0 op_sel:[1,0,0] op_sel_hi:[1,0,0]
    v_fma_mix_f32 v50, v38, v57, 0 op_sel_hi:[1,0,0]
    v_fma_mix_f32 v51, v38, v57, 0 op_sel:[1,0,0] op_sel_hi:[1,0,0]
    v_cvt_pk_bf16_f32 v34, v48, v49
    v_cvt_pk_bf16_f32 v38, v50, v51
    v_fma_mix_f32 v52, v42, v58, 0 op_sel_hi:[1,0,0]
    v_fma_mix_f32 v53, v42, v58, 0 op_sel:[1,0,0] op_sel_hi:[1,0,0]
    v_fma_mix_f32 v54, v46, v59, 0 op_sel_hi:[1,0,0]
    v_fma_mix_f32 v55, v46, v59, 0 op_sel:[1,0,0] op_sel_hi:[1,0,0]
    v_cvt_pk_bf16_f32 v42, v52, v53
    v_cvt_pk_bf16_f32 v46, v54, v55
    buffer_load_dwordx4 v[116:119], v13, s[20:23], s39 offen
    s_bfe_u32 s5, s41, 0x20015
    v_lshl_add_u32 v23, s5, 9, v26
    ds_read_b128 v[60:63], v23
    s_waitcnt lgkmcnt(1)
    v_fma_mix_f32 v48, v35, v56, 0 op_sel_hi:[1,0,0]
    v_fma_mix_f32 v49, v35, v56, 0 op_sel:[1,0,0] op_sel_hi:[1,0,0]
    v_fma_mix_f32 v50, v39, v57, 0 op_sel_hi:[1,0,0]
    v_fma_mix_f32 v51, v39, v57, 0 op_sel:[1,0,0] op_sel_hi:[1,0,0]
    v_cvt_pk_bf16_f32 v35, v48, v49
    v_cvt_pk_bf16_f32 v39, v50, v51
    buffer_load_dwordx4 v[120:123], v14, s[20:23], s39 offen
    ds_write_b128 v22, v[32:35] offset:32768
    buffer_load_dwordx4 v[124:127], v15, s[20:23], s39 offen
    ds_write_b128 v22, v[36:39] offset:33792
    buffer_load_dwordx4 v16, s[16:19], s99 offen offset:0 lds
    v_fma_mix_f32 v52, v43, v58, 0 op_sel_hi:[1,0,0]
    v_fma_mix_f32 v53, v43, v58, 0 op_sel:[1,0,0] op_sel_hi:[1,0,0]
    v_fma_mix_f32 v54, v47, v59, 0 op_sel_hi:[1,0,0]
    v_fma_mix_f32 v55, v47, v59, 0 op_sel:[1,0,0] op_sel_hi:[1,0,0]
    v_cvt_pk_bf16_f32 v43, v52, v53
    v_cvt_pk_bf16_f32 v47, v54, v55
    ds_write_b128 v22, v[40:43] offset:32896
    buffer_load_dwordx4 v17, s[16:19], s99 offen offset:1024 lds
    ds_write_b128 v22, v[44:47] offset:33920
    buffer_load_dwordx4 v18, s[16:19], s99 offen offset:2048 lds
    s_waitcnt vmcnt(9)
    v_lshl_add_u64 v[96:97], v[100:101], 4, v[96:97]
    v_lshl_add_u64 v[98:99], v[102:103], 4, v[98:99]
    v_fma_f64 v[96:97], v[96:97], s[10:11], v[24:25]
    v_fma_f64 v[98:99], v[98:99], s[10:11], v[24:25]
    ds_read_b32 v32, v96
    ds_read_b32 v36, v97
    ds_read_b32 v40, v98
    ds_read_b32 v44, v99
    buffer_load_dwordx4 v19, s[16:19], s99 offen offset:3072 lds
    s_add_u32 m0, s9, 106496
    s_waitcnt lgkmcnt(4)
    s_barrier
    buffer_load_dwordx4 v20, s[16:19], s99 offen offset:0 lds
    s_add_u32 m0, s9, 122880
    s_waitcnt vmcnt(9)
    v_lshl_add_u64 v[104:105], v[108:109], 4, v[104:105]
    v_lshl_add_u64 v[106:107], v[110:111], 4, v[106:107]
    v_fma_f64 v[104:105], v[104:105], s[10:11], v[24:25]
    v_fma_f64 v[106:107], v[106:107], s[10:11], v[24:25]
    ds_read_b32 v33, v104
    ds_read_b32 v37, v105
    ds_read_b32 v41, v106
    ds_read_b32 v45, v107
    buffer_load_dwordx4 v[64:67], v8, s[20:23], s48 offen
    s_waitcnt lgkmcnt(4)
    v_fma_mix_f32 v48, v32, v60, 0 op_sel_hi:[1,0,0]
    v_fma_mix_f32 v49, v32, v60, 0 op_sel:[1,0,0] op_sel_hi:[1,0,0]
    v_fma_mix_f32 v50, v36, v61, 0 op_sel_hi:[1,0,0]
    v_fma_mix_f32 v51, v36, v61, 0 op_sel:[1,0,0] op_sel_hi:[1,0,0]
    v_cvt_pk_bf16_f32 v32, v48, v49
    v_cvt_pk_bf16_f32 v36, v50, v51
    v_fma_mix_f32 v52, v40, v62, 0 op_sel_hi:[1,0,0]
    v_fma_mix_f32 v53, v40, v62, 0 op_sel:[1,0,0] op_sel_hi:[1,0,0]
    v_fma_mix_f32 v54, v44, v63, 0 op_sel_hi:[1,0,0]
    v_fma_mix_f32 v55, v44, v63, 0 op_sel:[1,0,0] op_sel_hi:[1,0,0]
    v_cvt_pk_bf16_f32 v40, v52, v53
    v_cvt_pk_bf16_f32 v44, v54, v55
    buffer_load_dwordx4 v[68:71], v9, s[20:23], s48 offen
    s_waitcnt vmcnt(9)
    v_lshl_add_u64 v[112:113], v[116:117], 4, v[112:113]
    v_lshl_add_u64 v[114:115], v[118:119], 4, v[114:115]
    v_fma_f64 v[112:113], v[112:113], s[10:11], v[24:25]
    v_fma_f64 v[114:115], v[114:115], s[10:11], v[24:25]
    ds_read_b32 v34, v112
    ds_read_b32 v38, v113
    ds_read_b32 v42, v114
    ds_read_b32 v46, v115
    buffer_load_dwordx4 v[72:75], v10, s[20:23], s48 offen
    s_waitcnt lgkmcnt(4)
    v_fma_mix_f32 v48, v33, v60, 0 op_sel_hi:[1,0,0]
    v_fma_mix_f32 v49, v33, v60, 0 op_sel:[1,0,0] op_sel_hi:[1,0,0]
    v_fma_mix_f32 v50, v37, v61, 0 op_sel_hi:[1,0,0]
    v_fma_mix_f32 v51, v37, v61, 0 op_sel:[1,0,0] op_sel_hi:[1,0,0]
    v_cvt_pk_bf16_f32 v33, v48, v49
    v_cvt_pk_bf16_f32 v37, v50, v51
    v_fma_mix_f32 v52, v41, v62, 0 op_sel_hi:[1,0,0]
    v_fma_mix_f32 v53, v41, v62, 0 op_sel:[1,0,0] op_sel_hi:[1,0,0]
    v_fma_mix_f32 v54, v45, v63, 0 op_sel_hi:[1,0,0]
    v_fma_mix_f32 v55, v45, v63, 0 op_sel:[1,0,0] op_sel_hi:[1,0,0]
    v_cvt_pk_bf16_f32 v41, v52, v53
    v_cvt_pk_bf16_f32 v45, v54, v55
    buffer_load_dwordx4 v[76:79], v11, s[20:23], s48 offen
    s_waitcnt vmcnt(9)
    v_lshl_add_u64 v[120:121], v[124:125], 4, v[120:121]
    v_lshl_add_u64 v[122:123], v[126:127], 4, v[122:123]
    v_fma_f64 v[120:121], v[120:121], s[10:11], v[24:25]
    v_fma_f64 v[122:123], v[122:123], s[10:11], v[24:25]
    ds_read_b32 v35, v120
    ds_read_b32 v39, v121
    ds_read_b32 v43, v122
    ds_read_b32 v47, v123
    buffer_load_dwordx4 v[80:83], v12, s[20:23], s48 offen
    s_waitcnt lgkmcnt(4)
    v_fma_mix_f32 v48, v34, v60, 0 op_sel_hi:[1,0,0]
    v_fma_mix_f32 v49, v34, v60, 0 op_sel:[1,0,0] op_sel_hi:[1,0,0]
    v_fma_mix_f32 v50, v38, v61, 0 op_sel_hi:[1,0,0]
    v_fma_mix_f32 v51, v38, v61, 0 op_sel:[1,0,0] op_sel_hi:[1,0,0]
    v_cvt_pk_bf16_f32 v34, v48, v49
    v_cvt_pk_bf16_f32 v38, v50, v51
    v_fma_mix_f32 v52, v42, v62, 0 op_sel_hi:[1,0,0]
    v_fma_mix_f32 v53, v42, v62, 0 op_sel:[1,0,0] op_sel_hi:[1,0,0]
    v_fma_mix_f32 v54, v46, v63, 0 op_sel_hi:[1,0,0]
    v_fma_mix_f32 v55, v46, v63, 0 op_sel:[1,0,0] op_sel_hi:[1,0,0]
    v_cvt_pk_bf16_f32 v42, v52, v53
    v_cvt_pk_bf16_f32 v46, v54, v55
    buffer_load_dwordx4 v[84:87], v13, s[20:23], s48 offen
    s_bfe_u32 s5, s41, 0x20019
    v_lshl_add_u32 v23, s5, 9, v26
    ds_read_b128 v[56:59], v23
    s_waitcnt lgkmcnt(1)
    v_fma_mix_f32 v48, v35, v60, 0 op_sel_hi:[1,0,0]
    v_fma_mix_f32 v49, v35, v60, 0 op_sel:[1,0,0] op_sel_hi:[1,0,0]
    v_fma_mix_f32 v50, v39, v61, 0 op_sel_hi:[1,0,0]
    v_fma_mix_f32 v51, v39, v61, 0 op_sel:[1,0,0] op_sel_hi:[1,0,0]
    v_cvt_pk_bf16_f32 v35, v48, v49
    v_cvt_pk_bf16_f32 v39, v50, v51
    buffer_load_dwordx4 v[88:91], v14, s[20:23], s48 offen
    ds_write_b128 v22, v[32:35] offset:49152
    buffer_load_dwordx4 v[92:95], v15, s[20:23], s48 offen
    ds_write_b128 v22, v[36:39] offset:50176
    buffer_load_dwordx4 v16, s[16:19], s100 offen offset:0 lds
    v_fma_mix_f32 v52, v43, v62, 0 op_sel_hi:[1,0,0]
    v_fma_mix_f32 v53, v43, v62, 0 op_sel:[1,0,0] op_sel_hi:[1,0,0]
    v_fma_mix_f32 v54, v47, v63, 0 op_sel_hi:[1,0,0]
    v_fma_mix_f32 v55, v47, v63, 0 op_sel:[1,0,0] op_sel_hi:[1,0,0]
    v_cvt_pk_bf16_f32 v43, v52, v53
    v_cvt_pk_bf16_f32 v47, v54, v55
    ds_write_b128 v22, v[40:43] offset:49280
    buffer_load_dwordx4 v17, s[16:19], s100 offen offset:1024 lds
    ds_write_b128 v22, v[44:47] offset:50304
    buffer_load_dwordx4 v18, s[16:19], s100 offen offset:2048 lds
    s_waitcnt vmcnt(9)
    v_lshl_add_u64 v[64:65], v[68:69], 4, v[64:65]
    v_lshl_add_u64 v[66:67], v[70:71], 4, v[66:67]
    v_fma_f64 v[64:65], v[64:65], s[10:11], v[24:25]
    v_fma_f64 v[66:67], v[66:67], s[10:11], v[24:25]
    ds_read_b32 v32, v64
    ds_read_b32 v36, v65
    ds_read_b32 v40, v66
    ds_read_b32 v44, v67
    buffer_load_dwordx4 v19, s[16:19], s100 offen offset:3072 lds
    s_add_u32 m0, s9, 126976
    s_branch L_pg1
.p2align 12
L_stub1:
    s_branch L_stub4
L_pg1:
    s_waitcnt lgkmcnt(4)
    s_barrier
    buffer_load_dwordx4 v20, s[16:19], s100 offen offset:0 lds
    s_add_u32 m0, s9, 143360
    s_waitcnt vmcnt(9)
    v_lshl_add_u64 v[72:73], v[76:77], 4, v[72:73]
    v_lshl_add_u64 v[74:75], v[78:79], 4, v[74:75]
    v_fma_f64 v[72:73], v[72:73], s[10:11], v[24:25]
    v_fma_f64 v[74:75], v[74:75], s[10:11], v[24:25]
    ds_read_b32 v33, v72
    ds_read_b32 v37, v73
    ds_read_b32 v41, v74
    ds_read_b32 v45, v75
    buffer_load_dwordx4 v[96:99], v8, s[20:23], s60 offen
    s_waitcnt lgkmcnt(4)
    v_fma_mix_f32 v48, v32, v56, 0 op_sel_hi:[1,0,0]
    v_fma_mix_f32 v49, v32, v56, 0 op_sel:[1,0,0] op_sel_hi:[1,0,0]
    v_fma_mix_f32 v50, v36, v57, 0 op_sel_hi:[1,0,0]
    v_fma_mix_f32 v51, v36, v57, 0 op_sel:[1,0,0] op_sel_hi:[1,0,0]
    v_cvt_pk_bf16_f32 v32, v48, v49
    v_cvt_pk_bf16_f32 v36, v50, v51
    v_fma_mix_f32 v52, v40, v58, 0 op_sel_hi:[1,0,0]
    v_fma_mix_f32 v53, v40, v58, 0 op_sel:[1,0,0] op_sel_hi:[1,0,0]
    v_fma_mix_f32 v54, v44, v59, 0 op_sel_hi:[1,0,0]
    v_fma_mix_f32 v55, v44, v59, 0 op_sel:[1,0,0] op_sel_hi:[1,0,0]
    v_cvt_pk_bf16_f32 v40, v52, v53
    v_cvt_pk_bf16_f32 v44, v54, v55
    buffer_load_dwordx4 v[100:103], v9, s[20:23], s60 offen
    s_waitcnt vmcnt(9)
    v_lshl_add_u64 v[80:81], v[84:85], 4, v[80:81]
    v_lshl_add_u64 v[82:83], v[86:87], 4, v[82:83]
    v_fma_f64 v[80:81], v[80:81], s[10:11], v[24:25]
    v_fma_f64 v[82:83], v[82:83], s[10:11], v[24:25]
    ds_read_b32 v34, v80
    ds_read_b32 v38, v81
    ds_read_b32 v42, v82
    ds_read_b32 v46, v83
    buffer_load_dwordx4 v[104:107], v10, s[20:23], s60 offen
    s_waitcnt lgkmcnt(4)
    v_fma_mix_f32 v48, v33, v56, 0 op_sel_hi:[1,0,0]
    v_fma_mix_f32 v49, v33, v56, 0 op_sel:[1,0,0] op_sel_hi:[1,0,0]
    v_fma_mix_f32 v50, v37, v57, 0 op_sel_hi:[1,0,0]
    v_fma_mix_f32 v51, v37, v57, 0 op_sel:[1,0,0] op_sel_hi:[1,0,0]
    v_cvt_pk_bf16_f32 v33, v48, v49
    v_cvt_pk_bf16_f32 v37, v50, v51
    v_fma_mix_f32 v52, v41, v58, 0 op_sel_hi:[1,0,0]
    v_fma_mix_f32 v53, v41, v58, 0 op_sel:[1,0,0] op_sel_hi:[1,0,0]
    v_fma_mix_f32 v54, v45, v59, 0 op_sel_hi:[1,0,0]
    v_fma_mix_f32 v55, v45, v59, 0 op_sel:[1,0,0] op_sel_hi:[1,0,0]
    v_cvt_pk_bf16_f32 v41, v52, v53
    v_cvt_pk_bf16_f32 v45, v54, v55
    buffer_load_dwordx4 v[108:111], v11, s[20:23], s60 offen
    s_waitcnt vmcnt(9)
    v_lshl_add_u64 v[88:89], v[92:93], 4, v[88:89]
    v_lshl_add_u64 v[90:91], v[94:95], 4, v[90:91]
    v_fma_f64 v[88:89], v[88:89], s[10:11], v[24:25]
    v_fma_f64 v[90:91], v[90:91], s[10:11], v[24:25]
    ds_read_b32 v35, v88
    ds_read_b32 v39, v89
    ds_read_b32 v43, v90
    ds_read_b32 v47, v91
    buffer_load_dwordx4 v[112:115], v12, s[20:23], s60 offen
    s_waitcnt lgkmcnt(4)
    v_fma_mix_f32 v48, v34, v56, 0 op_sel_hi:[1,0,0]
    v_fma_mix_f32 v49, v34, v56, 0 op_sel:[1,0,0] op_sel_hi:[1,0,0]
    v_fma_mix_f32 v50, v38, v57, 0 op_sel_hi:[1,0,0]
    v_fma_mix_f32 v51, v38, v57, 0 op_sel:[1,0,0] op_sel_hi:[1,0,0]
    v_cvt_pk_bf16_f32 v34, v48, v49
    v_cvt_pk_bf16_f32 v38, v50, v51
    v_fma_mix_f32 v52, v42, v58, 0 op_sel_hi:[1,0,0]
    v_fma_mix_f32 v53, v42, v58, 0 op_sel:[1,0,0] op_sel_hi:[1,0,0]
    v_fma_mix_f32 v54, v46, v59, 0 op_sel_hi:[1,0,0]
    v_fma_mix_f32 v55, v46, v59, 0 op_sel:[1,0,0] op_sel_hi:[1,0,0]
    v_cvt_pk_bf16_f32 v42, v52, v53
    v_cvt_pk_bf16_f32 v46, v54, v55
    buffer_load_dwordx4 v[116:119], v13, s[20:23], s60 offen
    s_bfe_u32 s5, s41, 0x2001d
    v_lshl_add_u32 v23, s5, 9, v26
    ds_read_b128 v[60:63], v23
    s_waitcnt lgkmcnt(1)
    v_fma_mix_f32 v48, v35, v56, 0 op_sel_hi:[1,0,0]
    v_fma_mix_f32 v49, v35, v56, 0 op_sel:[1,0,0] op_sel_hi:[1,0,0]
    v_fma_mix_f32 v50, v39, v57, 0 op_sel_hi:[1,0,0]
    v_fma_mix_f32 v51, v39, v57, 0 op_sel:[1,0,0] op_sel_hi:[1,0,0]
    v_cvt_pk_bf16_f32 v35, v48, v49
    v_cvt_pk_bf16_f32 v39, v50, v51
    buffer_load_dwordx4 v[120:123], v14, s[20:23], s60 offen
    ds_write_b128 v22, v[32:35] offset:32768
    buffer_load_dwordx4 v[124:127], v15, s[20:23], s60 offen
    ds_write_b128 v22, v[36:39] offset:33792
    buffer_load_dwordx4 v16, s[16:19], s101 offen offset:0 lds
    v_fma_mix_f32 v52, v43, v58, 0 op_sel_hi:[1,0,0]
    v_fma_mix_f32 v53, v43, v58, 0 op_sel:[1,0,0] op_sel_hi:[1,0,0]
    v_fma_mix_f32 v54, v47, v59, 0 op_sel_hi:[1,0,0]
    v_fma_mix_f32 v55, v47, v59, 0 op_sel:[1,0,0] op_sel_hi:[1,0,0]
    v_cvt_pk_bf16_f32 v43, v52, v53
    v_cvt_pk_bf16_f32 v47, v54, v55
    ds_write_b128 v22, v[40:43] offset:32896
    buffer_load_dwordx4 v17, s[16:19], s101 offen offset:1024 lds
    ds_write_b128 v22, v[44:47] offset:33920
    buffer_load_dwordx4 v18, s[16:19], s101 offen offset:2048 lds
    s_waitcnt vmcnt(9)
    v_lshl_add_u64 v[96:97], v[100:101], 4, v[96:97]
    v_lshl_add_u64 v[98:99], v[102:103], 4, v[98:99]
    v_fma_f64 v[96:97], v[96:97], s[10:11], v[24:25]
    v_fma_f64 v[98:99], v[98:99], s[10:11], v[24:25]
    ds_read_b32 v32, v96
    ds_read_b32 v36, v97
    ds_read_b32 v40, v98
    ds_read_b32 v44, v99
    buffer_load_dwordx4 v19, s[16:19], s101 offen offset:3072 lds
    s_add_u32 m0, s9, 147456
    s_waitcnt lgkmcnt(4)
    s_barrier
    s_waitcnt vmcnt(8)
    v_lshl_add_u64 v[104:105], v[108:109], 4, v[104:105]
    v_lshl_add_u64 v[106:107], v[110:111], 4, v[106:107]
    v_fma_f64 v[104:105], v[104:105], s[10:11], v[24:25]
    v_fma_f64 v[106:107], v[106:107], s[10:11], v[24:25]
    ds_read_b32 v33, v104
    ds_read_b32 v37, v105
    ds_read_b32 v41, v106
    ds_read_b32 v45, v107
    buffer_load_dwordx4 v20, s[16:19], s101 offen offset:0 lds
    s_add_u32 m0, s51, 65536
    s_waitcnt lgkmcnt(4)
    v_fma_mix_f32 v48, v32, v60, 0 op_sel_hi:[1,0,0]
    v_fma_mix_f32 v49, v32, v60, 0 op_sel:[1,0,0] op_sel_hi:[1,0,0]
    v_fma_mix_f32 v50, v36, v61, 0 op_sel_hi:[1,0,0]
    v_fma_mix_f32 v51, v36, v61, 0 op_sel:[1,0,0] op_sel_hi:[1,0,0]
    v_cvt_pk_bf16_f32 v32, v48, v49
    v_cvt_pk_bf16_f32 v36, v50, v51
    v_fma_mix_f32 v52, v40, v62, 0 op_sel_hi:[1,0,0]
    v_fma_mix_f32 v53, v40, v62, 0 op_sel:[1,0,0] op_sel_hi:[1,0,0]
    v_fma_mix_f32 v54, v44, v63, 0 op_sel_hi:[1,0,0]
    v_fma_mix_f32 v55, v44, v63, 0 op_sel:[1,0,0] op_sel_hi:[1,0,0]
    v_cvt_pk_bf16_f32 v40, v52, v53
    v_cvt_pk_bf16_f32 v44, v54, v55
    s_add_u32 s54, s52, s56
    buffer_load_dwordx4 v30, s[16:19], s54 offen offset:0 lds
    s_waitcnt vmcnt(8)
    v_lshl_add_u64 v[112:113], v[116:117], 4, v[112:113]
    v_lshl_add_u64 v[114:115], v[118:119], 4, v[114:115]
    v_fma_f64 v[112:113], v[112:113], s[10:11], v[24:25]
    v_fma_f64 v[114:115], v[114:115], s[10:11], v[24:25]
    ds_read_b32 v34, v112
    ds_read_b32 v38, v113
    ds_read_b32 v42, v114
    ds_read_b32 v46, v115
    buffer_load_dwordx4 v31, s[16:19], s54 offen offset:1024 lds
    s_add_u32 m0, s51, 67584
    s_waitcnt lgkmcnt(4)
    v_fma_mix_f32 v48, v33, v60, 0 op_sel_hi:[1,0,0]
    v_fma_mix_f32 v49, v33, v60, 0 op_sel:[1,0,0] op_sel_hi:[1,0,0]
    v_fma_mix_f32 v50, v37, v61, 0 op_sel_hi:[1,0,0]
    v_fma_mix_f32 v51, v37, v61, 0 op_sel:[1,0,0] op_sel_hi:[1,0,0]
    v_cvt_pk_bf16_f32 v33, v48, v49
    v_cvt_pk_bf16_f32 v37, v50, v51
    v_fma_mix_f32 v52, v41, v62, 0 op_sel_hi:[1,0,0]
    v_fma_mix_f32 v53, v41, v62, 0 op_sel:[1,0,0] op_sel_hi:[1,0,0]
    v_fma_mix_f32 v54, v45, v63, 0 op_sel_hi:[1,0,0]
    v_fma_mix_f32 v55, v45, v63, 0 op_sel:[1,0,0] op_sel_hi:[1,0,0]
    v_cvt_pk_bf16_f32 v41, v52, v53
    v_cvt_pk_bf16_f32 v45, v54, v55
    s_waitcnt vmcnt(7)
    v_lshl_add_u64 v[120:121], v[124:125], 4, v[120:121]
    v_lshl_add_u64 v[122:123], v[126:127], 4, v[122:123]
    v_fma_f64 v[120:121], v[120:121], s[10:11], v[24:25]
    v_fma_f64 v[122:123], v[122:123], s[10:11], v[24:25]
    s_add_u32 s54, s53, s56
    buffer_load_dwordx4 v30, s[16:19], s54 offen offset:0 lds
    ds_read_b32 v35, v120
    ds_read_b32 v39, v121
    ds_read_b32 v43, v122
    ds_read_b32 v47, v123
    s_waitcnt lgkmcnt(4)
    v_fma_mix_f32 v48, v34, v60, 0 op_sel_hi:[1,0,0]
    v_fma_mix_f32 v49, v34, v60, 0 op_sel:[1,0,0] op_sel_hi:[1,0,0]
    v_fma_mix_f32 v50, v38, v61, 0 op_sel_hi:[1,0,0]
    v_fma_mix_f32 v51, v38, v61, 0 op_sel:[1,0,0] op_sel_hi:[1,0,0]
    v_cvt_pk_bf16_f32 v34, v48, v49
    v_cvt_pk_bf16_f32 v38, v50, v51
    buffer_load_dwordx4 v31, s[16:19], s54 offen offset:1024 lds
    s_add_u32 m0, s51, 81920
    v_fma_mix_f32 v52, v42, v62, 0 op_sel_hi:[1,0,0]
    v_fma_mix_f32 v53, v42, v62, 0 op_sel:[1,0,0] op_sel_hi:[1,0,0]
    v_fma_mix_f32 v54, v46, v63, 0 op_sel_hi:[1,0,0]
    v_fma_mix_f32 v55, v46, v63, 0 op_sel:[1,0,0] op_sel_hi:[1,0,0]
    v_cvt_pk_bf16_f32 v42, v52, v53
    v_cvt_pk_bf16_f32 v46, v54, v55
    s_waitcnt lgkmcnt(0)
    v_fma_mix_f32 v48, v35, v60, 0 op_sel_hi:[1,0,0]
    v_fma_mix_f32 v49, v35, v60, 0 op_sel:[1,0,0] op_sel_hi:[1,0,0]
    v_fma_mix_f32 v50, v39, v61, 0 op_sel_hi:[1,0,0]
    v_fma_mix_f32 v51, v39, v61, 0 op_sel:[1,0,0] op_sel_hi:[1,0,0]
    v_cvt_pk_bf16_f32 v35, v48, v49
    v_cvt_pk_bf16_f32 v39, v50, v51
    s_add_u32 s56, s56, 16384
    s_cmp_eq_u32 s56, s58
    s_cselect_b32 s56, 0, s56
    s_add_u32 s54, s52, s56
    buffer_load_dwordx4 v30, s[16:19], s54 offen offset:0 lds
    ds_write_b128 v22, v[32:35] offset:49152
    ds_write_b128 v22, v[36:39] offset:50176
    buffer_load_dwordx4 v31, s[16:19], s54 offen offset:1024 lds
    s_add_u32 m0, s51, 83968
    v_fma_mix_f32 v52, v43, v62, 0 op_sel_hi:[1,0,0]
    v_fma_mix_f32 v53, v43, v62, 0 op_sel:[1,0,0] op_sel_hi:[1,0,0]
    v_fma_mix_f32 v54, v47, v63, 0 op_sel_hi:[1,0,0]
    v_fma_mix_f32 v55, v47, v63, 0 op_sel:[1,0,0] op_sel_hi:[1,0,0]
    v_cvt_pk_bf16_f32 v43, v52, v53
    v_cvt_pk_bf16_f32 v47, v54, v55
    ds_write_b128 v22, v[40:43] offset:49280
    s_add_u32 s54, s53, s56
    buffer_load_dwordx4 v30, s[16:19], s54 offen offset:0 lds
    ds_write_b128 v22, v[44:47] offset:50304
    buffer_load_dwordx4 v31, s[16:19], s54 offen offset:1024 lds
    s_add_u32 m0, s51, 98304
    s_waitcnt vmcnt(8)
    s_waitcnt lgkmcnt(0)
    s_barrier
    s_setprio 0
L_p2:
    s_add_u32 s56, s56, 16384
    s_cmp_eq_u32 s56, s58
    s_cselect_b32 s56, 0, s56
    s_add_u32 s54, s52, s56
    buffer_load_dwordx4 v30, s[16:19], s54 offen offset:0 lds
    buffer_load_dwordx4 v31, s[16:19], s54 offen offset:1024 lds
    s_add_u32 m0, s51, 100352
    s_add_u32 s54, s53, s56
    buffer_load_dwordx4 v30, s[16:19], s54 offen offset:0 lds
    buffer_load_dwordx4 v31, s[16:19], s54 offen offset:1024 lds
    s_add_u32 m0, s51, 114688
    s_add_u32 s56, s56, 16384
    s_cmp_eq_u32 s56, s58
    s_cselect_b32 s56, 0, s56
    s_add_u32 s54, s52, s56
    buffer_load_dwordx4 v30, s[16:19], s54 offen offset:0 lds
    buffer_load_dwordx4 v31, s[16:19], s54 offen offset:1024 lds
    s_add_u32 m0, s51, 116736
    s_add_u32 s54, s53, s56
    buffer_load_dwordx4 v30, s[16:19], s54 offen offset:0 lds
    buffer_load_dwordx4 v31, s[16:19], s54 offen offset:1024 lds
    s_add_u32 m0, s51, 0
    s_add_u32 s56, s56, 16384
    s_cmp_eq_u32 s56, s58
    s_cselect_b32 s56, 0, s56
    s_add_u32 s54, s52, s56
    buffer_load_dwordx4 v30, s[16:19], s54 offen offset:0 lds
    buffer_load_dwordx4 v31, s[16:19], s54 offen offset:1024 lds
    s_add_u32 m0, s51, 2048
    s_waitcnt vmcnt(14)
    s_barrier
    s_add_u32 s54, s53, s56
    buffer_load_dwordx4 v30, s[16:19], s54 offen offset:0 lds
    buffer_load_dwordx4 v31, s[16:19], s54 offen offset:1024 lds
    s_add_u32 m0, s51, 32768
    s_add_u32 s56, s56, 16384
    s_cmp_eq_u32 s56, s58
    s_cselect_b32 s56, 0, s56
    s_add_u32 s54, s52, s56
    buffer_load_dwordx4 v30, s[16:19], s54 offen offset:0 lds
    buffer_load_dwordx4 v31, s[16:19], s54 offen offset:1024 lds
    s_add_u32 m0, s51, 34816
    s_add_u32 s54, s53, s56
    buffer_load_dwordx4 v30, s[16:19], s54 offen offset:0 lds
    buffer_load_dwordx4 v31, s[16:19], s54 offen offset:1024 lds
    s_add_u32 m0, s51, 16384
    s_waitcnt vmcnt(16)
    s_barrier
    s_add_u32 s56, s56, 16384
    s_cmp_eq_u32 s56, s58
    s_cselect_b32 s56, 0, s56
    s_add_u32 s54, s52, s56
    buffer_load_dwordx4 v30, s[16:19], s54 offen offset:0 lds
    buffer_load_dwordx4 v31, s[16:19], s54 offen offset:1024 lds
    s_add_u32 m0, s51, 18432
    s_add_u32 s54, s53, s56
    buffer_load_dwordx4 v30, s[16:19], s54 offen offset:0 lds
    buffer_load_dwordx4 v31, s[16:19], s54 offen offset:1024 lds
    s_add_u32 m0, s51, 131072
    s_add_u32 s56, s56, 16384
    s_cmp_eq_u32 s56, s58
    s_cselect_b32 s56, 0, s56
    s_add_u32 s54, s52, s56
    buffer_load_dwordx4 v30, s[16:19], s54 offen offset:0 lds
    buffer_load_dwordx4 v31, s[16:19], s54 offen offset:1024 lds
    s_add_u32 m0, s51, 133120
    s_waitcnt vmcnt(14)
    s_barrier
    s_add_u32 s54, s53, s56
    buffer_load_dwordx4 v30, s[16:19], s54 offen offset:0 lds
    buffer_load_dwordx4 v31, s[16:19], s54 offen offset:1024 lds
    s_add_u32 m0, s51, 147456
    s_waitcnt vmcnt(8)
    s_cmp_ge_u32 s37, 2
    s_cbranch_scc1 L_sk10
    s_add_u32 s56, s56, 16384
    s_cmp_eq_u32 s56, s58
    s_cselect_b32 s56, 0, s56
    s_add_u32 s54, s52, s56
    buffer_load_dwordx4 v30, s[16:19], s54 offen offset:0 lds
    buffer_load_dwordx4 v31, s[16:19], s54 offen offset:1024 lds
    s_add_u32 m0, s51, 149504
    s_add_u32 s54, s53, s56
    buffer_load_dwordx4 v30, s[16:19], s54 offen offset:0 lds
    buffer_load_dwordx4 v31, s[16:19], s54 offen offset:1024 lds
L_sk10:
    s_barrier
    s_waitcnt vmcnt(4)
    s_barrier
    s_waitcnt vmcnt(0)
    s_barrier
L_pdone:
L_end:
    s_endpgm
L_idle:
    s_endpgm
.p2align 6
L_cons:
    s_load_dwordx2 s[28:29], s[0:1], 24
    s_and_b32 s3, s2, 1
    s_lshl_b32 s3, s3, 5
    s_lshr_b32 s4, s2, 3
    s_add_u32 s3, s3, s4
    s_cmp_ge_u32 s4, 32
    s_cselect_b32 s3, 63, s3
    s_cmp_ge_u32 s3, 63
    s_cbranch_scc1 L_idle
    s_mul_i32 s40, s3, 37
    s_lshr_b32 s40, s40, 8
    s_mul_i32 s6, s40, 7
    s_sub_u32 s37, s3, s6
    s_bfe_u32 s6, s2, 0x20001
    s_mul_i32 s6, s6, 9
    s_add_u32 s36, s6, s40
    s_mov_b32 s23, 0x00020000
    v_and_b32 v1, 63, v0
    s_lshl_b32 s6, s42, 12
    v_lshrrev_b32 v12, 3, v1
    v_lshrrev_b32 v13, 1, v12
    v_and_b32 v12, 1, v12
    v_lshlrev_b32 v12, 4, v12
    v_mov_b32 v14, 0xb990bc00
    v_mov_b32 v15, 0x31282d18
    v_cmp_eq_u32 vcc, 1, v13
    v_mov_b32 v16, 0xb650b830
    v_mov_b32 v17, 0x356833e0
    v_cndmask_b32 v14, v14, v16, vcc
    v_cndmask_b32 v15, v15, v17, vcc
    v_cmp_eq_u32 vcc, 2, v13
    v_mov_b32 v16, 0xb1e8b490
    v_mov_b32 v17, 0x38803710
    v_cndmask_b32 v14, v14, v16, vcc
    v_cndmask_b32 v15, v15, v17, vcc
    v_cmp_eq_u32 vcc, 3, v13
    v_mov_b32 v16, 0xadd0
    v_mov_b32 v17, 0x3c0039c8
    v_cndmask_b32 v14, v14, v16, vcc
    v_cndmask_b32 v15, v15, v17, vcc
    v_bfe_u32 v14, v14, v12, 16
    v_bfe_u32 v15, v15, v12, 16
    s_mov_b32 s8, 0xb990bc00
    s_mov_b32 s9, 0xb650b830
    s_cmp_eq_u32 s42, 1
    s_cselect_b32 s8, 0xb1e8b490, s8
    s_cselect_b32 s9, 0xadd0, s9
    s_cmp_eq_u32 s42, 2
    s_cselect_b32 s8, 0x31282d18, s8
    s_cselect_b32 s9, 0x356833e0, s9
    s_cmp_eq_u32 s42, 3
    s_cselect_b32 s8, 0x38803710, s8
    s_cselect_b32 s9, 0x3c0039c8, s9
    s_lshl_b32 s5, s42, 13
    v_lshl_add_u32 v30, v1, 4, s5
    s_lshl_b32 s5, s8, 16
    v_or_b32 v16, s5, v14
    v_or_b32 v17, s5, v14
    v_or_b32 v18, s5, v14
    v_or_b32 v19, s5, v14
    ds_write_b128 v30, v[16:19] offset:0
    v_or_b32 v20, s5, v15
    v_or_b32 v21, s5, v15
    v_or_b32 v22, s5, v15
    v_or_b32 v23, s5, v15
    ds_write_b128 v30, v[20:23] offset:1024
    s_and_b32 s5, s8, 0xffff0000
    v_or_b32 v24, s5, v14
    v_or_b32 v25, s5, v14
    v_or_b32 v26, s5, v14
    v_or_b32 v27, s5, v14
    ds_write_b128 v30, v[24:27] offset:2048
    v_or_b32 v16, s5, v15
    v_or_b32 v17, s5, v15
    v_or_b32 v18, s5, v15
    v_or_b32 v19, s5, v15
    ds_write_b128 v30, v[16:19] offset:3072
    s_lshl_b32 s5, s9, 16
    v_or_b32 v20, s5, v14
    v_or_b32 v21, s5, v14
    v_or_b32 v22, s5, v14
    v_or_b32 v23, s5, v14
    ds_write_b128 v30, v[20:23] offset:4096
    v_or_b32 v24, s5, v15
    v_or_b32 v25, s5, v15
    v_or_b32 v26, s5, v15
    v_or_b32 v27, s5, v15
    ds_write_b128 v30, v[24:27] offset:5120
    s_and_b32 s5, s9, 0xffff0000
    v_or_b32 v16, s5, v14
    v_or_b32 v17, s5, v14
    v_or_b32 v18, s5, v14
    v_or_b32 v19, s5, v14
    ds_write_b128 v30, v[16:19] offset:6144
    v_or_b32 v20, s5, v15
    v_or_b32 v21, s5, v15
    v_or_b32 v22, s5, v15
    v_or_b32 v23, s5, v15
    ds_write_b128 v30, v[20:23] offset:7168
    s_waitcnt lgkmcnt(0)
    s_barrier
    s_mov_b32 s19, s23
    s_mov_b32 s18, 2097152
    s_min_u32 s5, s37, 2
    s_mul_i32 s60, s37, 18
    s_add_u32 s60, s60, s5
    s_lshl_b32 s60, s60, 14
    s_lshl_b32 s5, s36, 2
    s_add_u32 s5, s5, s42
    s_mul_i32 s7, s5, 1152
    s_add_u32 s7, s7, s60
    v_lshlrev_b32 v31, 4, v1
    buffer_load_dwordx4 v[116:119], v31, s[16:19], s7 offen
    s_mov_b64 exec, 0xff
    buffer_load_dwordx4 v[120:123], v31, s[16:19], s7 offen offset:1024
    s_mov_b64 exec, -1
    v_and_b32 v40, 15, v1
    v_lshrrev_b32 v41, 4, v1
    v_lshrrev_b32 v42, 1, v40
    v_and_b32 v43, 1, v40
    v_lshl_add_u32 v43, v43, 3, v42
    v_xor_b32 v42, v42, v41
    v_lshlrev_b32 v42, 4, v42
    v_lshl_add_u32 v0, v40, 7, v42
    v_add_u32 v0, 102400, v0
    v_xor_b32 v1, 64, v0
    v_lshlrev_b32 v43, 4, v43
    v_lshl_add_u32 v43, v41, 8, v43
    v_add_u32 v2, s6, v43
    s_mov_b32 s31, s23
    s_mov_b32 s30, 18874368
    v_mul_u32_u24 v41, 36864, v41
    v_lshl_add_u32 v4, v40, 2, v41
    v_add_u32 v5, 9216, v4
    v_add_u32 v6, 18432, v4
    v_add_u32 v7, 27648, v4
    s_min_u32 s5, s37, 2
    s_mul_i32 s38, s37, 18
    s_add_u32 s38, s38, s5
    s_mul_i32 s50, s38, 147456
    s_lshl_b32 s5, s36, 8
    s_add_u32 s50, s50, s5
    s_lshl_b32 s5, s42, 6
    s_add_u32 s50, s50, s5
    s_add_u32 s49, s50, 1474560
    s_cmp_lt_u32 s37, 2
    s_cselect_b32 s59, 9, 8
    s_mul_i32 s59, s59, 147456
    s_lshl_b32 s5, s40, 2
    s_lshr_b32 s5, 0x40404040, s5
    s_and_b32 s5, s5, 15
    s_mul_i32 s57, s5, 147456
    s_add_u32 s10, s57, s49
    s_add_u32 s57, s57, 147456
    s_cmp_eq_u32 s57, s59
    s_cselect_b32 s57, 0, s57
    s_add_u32 s11, s57, s49
    s_add_u32 s57, s57, 147456
    s_cmp_eq_u32 s57, s59
    s_cselect_b32 s57, 0, s57
    s_add_u32 s14, s57, s49
    s_add_u32 s57, s57, 147456
    s_cmp_eq_u32 s57, s59
    s_cselect_b32 s57, 0, s57
    s_add_u32 s20, s57, s49
    s_add_u32 s57, s57, 147456
    s_cmp_eq_u32 s57, s59
    s_cselect_b32 s57, 0, s57
    s_add_u32 s21, s57, s49
    s_add_u32 s57, s57, 147456
    s_cmp_eq_u32 s57, s59
    s_cselect_b32 s57, 0, s57
    s_add_u32 s22, s57, s49
    s_add_u32 s57, s57, 147456
    s_cmp_eq_u32 s57, s59
    s_cselect_b32 s57, 0, s57
    s_add_u32 s24, s57, s49
    s_add_u32 s57, s57, 147456
    s_cmp_eq_u32 s57, s59
    s_cselect_b32 s57, 0, s57
    s_add_u32 s25, s57, s49
    s_add_u32 s57, s57, 147456
    s_cmp_eq_u32 s57, s59
    s_cselect_b32 s57, 0, s57
    s_add_u32 s26, s57, s49
    s_cmp_eq_u32 s42, 0
    s_cbranch_scc1 L_stub0
    s_cmp_eq_u32 s42, 1
    s_cbranch_scc1 L_stub1
    s_cmp_eq_u32 s42, 2
    s_cbranch_scc1 L_stub2
    s_branch L_stub3
L_warmed:
    s_barrier
    ds_read_b128 a[0:3], v2 offset:32768
    ds_read_b128 v[8:11], v0 offset:20480
    ds_read_b128 a[8:11], v2 offset:34816
    ds_read_b128 v[12:15], v1 offset:20480
    ds_read_b128 a[4:7], v2 offset:33792
    ds_read_b128 a[12:15], v2 offset:35840
    ds_read_b128 v[16:19], v0 offset:22528
    ds_read_b128 v[20:23], v1 offset:22528
    ds_read_b128 v[24:27], v0 offset:24576
    ds_read_b128 v[28:31], v1 offset:24576
    s_waitcnt lgkmcnt(8)
    v_mfma_f32_16x16x32_bf16 v[48:51], v[8:11], a[0:3], 0
    ds_read_b128 v[32:35], v0 offset:26624
    s_waitcnt lgkmcnt(7)
    v_mfma_f32_16x16x32_bf16 v[48:51], v[12:15], a[8:11], v[48:51]
    ds_read_b128 v[36:39], v1 offset:26624
    s_waitcnt lgkmcnt(7)
    v_mfma_f32_16x16x32_bf16 v[52:55], v[8:11], a[4:7], 0
    ds_read_b128 v[40:43], v0 offset:28672
    s_waitcnt lgkmcnt(7)
    v_mfma_f32_16x16x32_bf16 v[52:55], v[12:15], a[12:15], v[52:55]
    ds_read_b128 v[44:47], v1 offset:28672
    s_waitcnt lgkmcnt(7)
    v_mfma_f32_16x16x32_bf16 v[56:59], v[16:19], a[0:3], 0
    s_waitcnt lgkmcnt(6)
    v_mfma_f32_16x16x32_bf16 v[56:59], v[20:23], a[8:11], v[56:59]
    v_mfma_f32_16x16x32_bf16 v[60:63], v[16:19], a[4:7], 0
    ds_read_b128 v[8:11], v0 offset:30720
    v_mfma_f32_16x16x32_bf16 v[60:63], v[20:23], a[12:15], v[60:63]
    ds_read_b128 v[12:15], v1 offset:30720
    s_waitcnt lgkmcnt(6)
    v_mfma_f32_16x16x32_bf16 v[64:67], v[24:27], a[0:3], 0
    v_mfma_f32_16x16x32_bf16 v[64:67], v[28:31], a[8:11], v[64:67]
    v_mfma_f32_16x16x32_bf16 v[68:71], v[24:27], a[4:7], 0
    ds_read_b128 v[16:19], v0 offset:32768
    v_mfma_f32_16x16x32_bf16 v[68:71], v[28:31], a[12:15], v[68:71]
    ds_read_b128 v[20:23], v1 offset:32768
    s_waitcnt lgkmcnt(6)
    v_mfma_f32_16x16x32_bf16 v[72:75], v[32:35], a[0:3], 0
    v_mfma_f32_16x16x32_bf16 v[72:75], v[36:39], a[8:11], v[72:75]
    v_mfma_f32_16x16x32_bf16 v[76:79], v[32:35], a[4:7], 0
    ds_read_b128 v[24:27], v0 offset:34816
    v_mfma_f32_16x16x32_bf16 v[76:79], v[36:39], a[12:15], v[76:79]
    ds_read_b128 v[28:31], v1 offset:34816
    s_waitcnt lgkmcnt(6)
    v_mfma_f32_16x16x32_bf16 v[80:83], v[40:43], a[0:3], 0
    v_mfma_f32_16x16x32_bf16 v[80:83], v[44:47], a[8:11], v[80:83]
    v_mfma_f32_16x16x32_bf16 v[84:87], v[40:43], a[4:7], 0
    ds_read_b128 v[32:35], v0 offset:36864
    v_mfma_f32_16x16x32_bf16 v[84:87], v[44:47], a[12:15], v[84:87]
    ds_read_b128 v[36:39], v1 offset:36864
    s_waitcnt lgkmcnt(6)
    v_mfma_f32_16x16x32_bf16 v[88:91], v[8:11], a[0:3], 0
    v_mfma_f32_16x16x32_bf16 v[88:91], v[12:15], a[8:11], v[88:91]
    v_mfma_f32_16x16x32_bf16 v[92:95], v[8:11], a[4:7], 0
    ds_read_b128 v[40:43], v0 offset:38912
    v_mfma_f32_16x16x32_bf16 v[92:95], v[12:15], a[12:15], v[92:95]
    ds_read_b128 v[44:47], v1 offset:38912
    s_waitcnt lgkmcnt(6)
    v_mfma_f32_16x16x32_bf16 v[96:99], v[16:19], a[0:3], 0
    v_mfma_f32_16x16x32_bf16 v[96:99], v[20:23], a[8:11], v[96:99]
    v_mfma_f32_16x16x32_bf16 v[100:103], v[16:19], a[4:7], 0
    v_mfma_f32_16x16x32_bf16 v[100:103], v[20:23], a[12:15], v[100:103]
    s_waitcnt lgkmcnt(4)
    v_mfma_f32_16x16x32_bf16 v[104:107], v[24:27], a[0:3], 0
    v_mfma_f32_16x16x32_bf16 v[104:107], v[28:31], a[8:11], v[104:107]
    v_mfma_f32_16x16x32_bf16 v[108:111], v[24:27], a[4:7], 0
    v_mfma_f32_16x16x32_bf16 v[108:111], v[28:31], a[12:15], v[108:111]
    s_waitcnt lgkmcnt(0)
    s_branch L_pg2
.p2align 12
L_stub2:
    s_branch L_warmed
L_pg2:
    s_barrier
    ds_read_b128 a[16:19], v2 offset:49152
    ds_read_b128 v[8:11], v0 offset:40960
    ds_read_b128 a[24:27], v2 offset:51200
    ds_read_b128 v[12:15], v1 offset:40960
    s_waitcnt vmcnt(0)
    v_mfma_f32_16x16x32_bf16 v[112:115], v[32:35], a[0:3], 0
    ds_read_b128 a[28:31], v2 offset:52224
    v_mfma_f32_16x16x32_bf16 v[112:115], v[36:39], a[8:11], v[112:115]
    ds_read_b128 a[20:23], v2 offset:50176
    v_mfma_f32_16x16x32_bf16 v[116:119], v[32:35], a[4:7], 0
    ds_read_b128 v[16:19], v0 offset:43008
    v_mfma_f32_16x16x32_bf16 v[116:119], v[36:39], a[12:15], v[116:119]
    ds_read_b128 v[20:23], v1 offset:43008
    v_mfma_f32_16x16x32_bf16 v[120:123], v[40:43], a[0:3], 0
    ds_read_b128 v[24:27], v0 offset:45056
    v_mfma_f32_16x16x32_bf16 v[120:123], v[44:47], a[8:11], v[120:123]
    ds_read_b128 v[28:31], v1 offset:45056
    v_mfma_f32_16x16x32_bf16 v[124:127], v[40:43], a[4:7], 0
    ds_read_b128 v[32:35], v0 offset:47104
    v_mfma_f32_16x16x32_bf16 v[124:127], v[44:47], a[12:15], v[124:127]
    ds_read_b128 v[36:39], v1 offset:47104
    s_waitcnt lgkmcnt(6)
    v_mfma_f32_16x16x32_bf16 v[48:51], v[8:11], a[16:19], v[48:51]
    v_mfma_f32_16x16x32_bf16 v[48:51], v[12:15], a[24:27], v[48:51]
    v_mfma_f32_16x16x32_bf16 v[52:55], v[12:15], a[28:31], v[52:55]
    ds_read_b128 v[40:43], v0 offset:49152
    v_mfma_f32_16x16x32_bf16 v[52:55], v[8:11], a[20:23], v[52:55]
    ds_read_b128 v[44:47], v1 offset:49152
    s_waitcnt lgkmcnt(6)
    v_mfma_f32_16x16x32_bf16 v[60:63], v[16:19], a[20:23], v[60:63]
    v_mfma_f32_16x16x32_bf16 v[60:63], v[20:23], a[28:31], v[60:63]
    v_mfma_f32_16x16x32_bf16 v[56:59], v[20:23], a[24:27], v[56:59]
    ds_read_b128 v[12:15], v0 offset:51200
    v_mfma_f32_16x16x32_bf16 v[56:59], v[16:19], a[16:19], v[56:59]
    ds_read_b128 v[8:11], v1 offset:51200
    s_waitcnt lgkmcnt(6)
    v_mfma_f32_16x16x32_bf16 v[64:67], v[24:27], a[16:19], v[64:67]
    v_mfma_f32_16x16x32_bf16 v[64:67], v[28:31], a[24:27], v[64:67]
    v_mfma_f32_16x16x32_bf16 v[68:71], v[28:31], a[28:31], v[68:71]
    ds_read_b128 v[20:23], v0 offset:53248
    v_mfma_f32_16x16x32_bf16 v[68:71], v[24:27], a[20:23], v[68:71]
    ds_read_b128 v[16:19], v1 offset:53248
    s_waitcnt lgkmcnt(6)
    v_mfma_f32_16x16x32_bf16 v[76:79], v[32:35], a[20:23], v[76:79]
    v_mfma_f32_16x16x32_bf16 v[76:79], v[36:39], a[28:31], v[76:79]
    v_mfma_f32_16x16x32_bf16 v[72:75], v[36:39], a[24:27], v[72:75]
    ds_read_b128 v[28:31], v0 offset:55296
    v_mfma_f32_16x16x32_bf16 v[72:75], v[32:35], a[16:19], v[72:75]
    ds_read_b128 v[24:27], v1 offset:55296
    s_waitcnt lgkmcnt(6)
    v_mfma_f32_16x16x32_bf16 v[80:83], v[40:43], a[16:19], v[80:83]
    v_mfma_f32_16x16x32_bf16 v[80:83], v[44:47], a[24:27], v[80:83]
    v_mfma_f32_16x16x32_bf16 v[84:87], v[44:47], a[28:31], v[84:87]
    ds_read_b128 v[36:39], v0 offset:57344
    v_mfma_f32_16x16x32_bf16 v[84:87], v[40:43], a[20:23], v[84:87]
    ds_read_b128 v[32:35], v1 offset:57344
    s_waitcnt lgkmcnt(6)
    v_mfma_f32_16x16x32_bf16 v[92:95], v[12:15], a[20:23], v[92:95]
    v_mfma_f32_16x16x32_bf16 v[92:95], v[8:11], a[28:31], v[92:95]
    v_mfma_f32_16x16x32_bf16 v[88:91], v[8:11], a[24:27], v[88:91]
    ds_read_b128 v[44:47], v0 offset:59392
    v_mfma_f32_16x16x32_bf16 v[88:91], v[12:15], a[16:19], v[88:91]
    ds_read_b128 v[40:43], v1 offset:59392
    s_waitcnt lgkmcnt(6)
    v_mfma_f32_16x16x32_bf16 v[96:99], v[20:23], a[16:19], v[96:99]
    v_mfma_f32_16x16x32_bf16 v[96:99], v[16:19], a[24:27], v[96:99]
    v_mfma_f32_16x16x32_bf16 v[100:103], v[16:19], a[28:31], v[100:103]
    v_mfma_f32_16x16x32_bf16 v[100:103], v[20:23], a[20:23], v[100:103]
    s_waitcnt lgkmcnt(4)
    v_mfma_f32_16x16x32_bf16 v[108:111], v[28:31], a[20:23], v[108:111]
    v_mfma_f32_16x16x32_bf16 v[108:111], v[24:27], a[28:31], v[108:111]
    v_mfma_f32_16x16x32_bf16 v[104:107], v[24:27], a[24:27], v[104:107]
    v_mfma_f32_16x16x32_bf16 v[104:107], v[28:31], a[16:19], v[104:107]
    s_waitcnt lgkmcnt(0)
    s_barrier
    ds_read_b128 a[32:35], v2 offset:32768
    ds_read_b128 v[8:11], v0 offset:0
    ds_read_b128 a[40:43], v2 offset:34816
    ds_read_b128 v[12:15], v1 offset:0
    v_mfma_f32_16x16x32_bf16 v[112:115], v[36:39], a[16:19], v[112:115]
    ds_read_b128 a[44:47], v2 offset:35840
    v_mfma_f32_16x16x32_bf16 v[112:115], v[32:35], a[24:27], v[112:115]
    ds_read_b128 a[36:39], v2 offset:33792
    v_mfma_f32_16x16x32_bf16 v[116:119], v[32:35], a[28:31], v[116:119]
    ds_read_b128 v[16:19], v0 offset:2048
    v_mfma_f32_16x16x32_bf16 v[116:119], v[36:39], a[20:23], v[116:119]
    ds_read_b128 v[20:23], v1 offset:2048
    v_mfma_f32_16x16x32_bf16 v[124:127], v[44:47], a[20:23], v[124:127]
    ds_read_b128 v[24:27], v0 offset:4096
    v_mfma_f32_16x16x32_bf16 v[124:127], v[40:43], a[28:31], v[124:127]
    ds_read_b128 v[28:31], v1 offset:4096
    v_mfma_f32_16x16x32_bf16 v[120:123], v[40:43], a[24:27], v[120:123]
    ds_read_b128 v[32:35], v0 offset:6144
    v_mfma_f32_16x16x32_bf16 v[120:123], v[44:47], a[16:19], v[120:123]
    ds_read_b128 v[36:39], v1 offset:6144
    s_waitcnt lgkmcnt(6)
    v_mfma_f32_16x16x32_bf16 v[48:51], v[8:11], a[32:35], v[48:51]
    v_mfma_f32_16x16x32_bf16 v[48:51], v[12:15], a[40:43], v[48:51]
    v_mfma_f32_16x16x32_bf16 v[52:55], v[12:15], a[44:47], v[52:55]
    ds_read_b128 v[40:43], v0 offset:8192
    v_mfma_f32_16x16x32_bf16 v[52:55], v[8:11], a[36:39], v[52:55]
    ds_read_b128 v[44:47], v1 offset:8192
    s_waitcnt lgkmcnt(6)
    v_mfma_f32_16x16x32_bf16 v[60:63], v[16:19], a[36:39], v[60:63]
    v_mfma_f32_16x16x32_bf16 v[60:63], v[20:23], a[44:47], v[60:63]
    v_mfma_f32_16x16x32_bf16 v[56:59], v[20:23], a[40:43], v[56:59]
    ds_read_b128 v[12:15], v0 offset:10240
    v_mfma_f32_16x16x32_bf16 v[56:59], v[16:19], a[32:35], v[56:59]
    ds_read_b128 v[8:11], v1 offset:10240
    s_waitcnt lgkmcnt(6)
    v_mfma_f32_16x16x32_bf16 v[64:67], v[24:27], a[32:35], v[64:67]
    v_mfma_f32_16x16x32_bf16 v[64:67], v[28:31], a[40:43], v[64:67]
    v_mfma_f32_16x16x32_bf16 v[68:71], v[28:31], a[44:47], v[68:71]
    ds_read_b128 v[20:23], v0 offset:12288
    v_mfma_f32_16x16x32_bf16 v[68:71], v[24:27], a[36:39], v[68:71]
    ds_read_b128 v[16:19], v1 offset:12288
    s_waitcnt lgkmcnt(6)
    v_mfma_f32_16x16x32_bf16 v[76:79], v[32:35], a[36:39], v[76:79]
    v_mfma_f32_16x16x32_bf16 v[76:79], v[36:39], a[44:47], v[76:79]
    v_mfma_f32_16x16x32_bf16 v[72:75], v[36:39], a[40:43], v[72:75]
    ds_read_b128 v[28:31], v0 offset:14336
    v_mfma_f32_16x16x32_bf16 v[72:75], v[32:35], a[32:35], v[72:75]
    ds_read_b128 v[24:27], v1 offset:14336
    s_waitcnt lgkmcnt(6)
    v_mfma_f32_16x16x32_bf16 v[80:83], v[40:43], a[32:35], v[80:83]
    v_mfma_f32_16x16x32_bf16 v[80:83], v[44:47], a[40:43], v[80:83]
    v_mfma_f32_16x16x32_bf16 v[84:87], v[44:47], a[44:47], v[84:87]
    ds_read_b128 v[36:39], v0 offset:16384
    v_mfma_f32_16x16x32_bf16 v[84:87], v[40:43], a[36:39], v[84:87]
    ds_read_b128 v[32:35], v1 offset:16384
    s_waitcnt lgkmcnt(6)
    v_mfma_f32_16x16x32_bf16 v[92:95], v[12:15], a[36:39], v[92:95]
    v_mfma_f32_16x16x32_bf16 v[92:95], v[8:11], a[44:47], v[92:95]
    v_mfma_f32_16x16x32_bf16 v[88:91], v[8:11], a[40:43], v[88:91]
    ds_read_b128 v[44:47], v0 offset:18432
    v_mfma_f32_16x16x32_bf16 v[88:91], v[12:15], a[32:35], v[88:91]
    ds_read_b128 v[40:43], v1 offset:18432
    s_waitcnt lgkmcnt(6)
    v_mfma_f32_16x16x32_bf16 v[96:99], v[20:23], a[32:35], v[96:99]
    v_mfma_f32_16x16x32_bf16 v[96:99], v[16:19], a[40:43], v[96:99]
    v_mfma_f32_16x16x32_bf16 v[100:103], v[16:19], a[44:47], v[100:103]
    v_mfma_f32_16x16x32_bf16 v[100:103], v[20:23], a[36:39], v[100:103]
    s_waitcnt lgkmcnt(4)
    v_mfma_f32_16x16x32_bf16 v[108:111], v[28:31], a[36:39], v[108:111]
    v_mfma_f32_16x16x32_bf16 v[108:111], v[24:27], a[44:47], v[108:111]
    v_mfma_f32_16x16x32_bf16 v[104:107], v[24:27], a[40:43], v[104:107]
    v_mfma_f32_16x16x32_bf16 v[104:107], v[28:31], a[32:35], v[104:107]
    s_waitcnt lgkmcnt(0)
    s_barrier
    ds_read_b128 a[48:51], v2 offset:49152
    ds_read_b128 v[8:11], v0 offset:20480
    ds_read_b128 a[56:59], v2 offset:51200
    ds_read_b128 v[12:15], v1 offset:20480
    v_mfma_f32_16x16x32_bf16 v[112:115], v[36:39], a[32:35], v[112:115]
    ds_read_b128 a[60:63], v2 offset:52224
    v_mfma_f32_16x16x32_bf16 v[112:115], v[32:35], a[40:43], v[112:115]
    ds_read_b128 a[52:55], v2 offset:50176
    v_mfma_f32_16x16x32_bf16 v[116:119], v[32:35], a[44:47], v[116:119]
    ds_read_b128 v[16:19], v0 offset:22528
    v_mfma_f32_16x16x32_bf16 v[116:119], v[36:39], a[36:39], v[116:119]
    ds_read_b128 v[20:23], v1 offset:22528
    v_mfma_f32_16x16x32_bf16 v[124:127], v[44:47], a[36:39], v[124:127]
    ds_read_b128 v[24:27], v0 offset:24576
    v_mfma_f32_16x16x32_bf16 v[124:127], v[40:43], a[44:47], v[124:127]
    ds_read_b128 v[28:31], v1 offset:24576
    v_mfma_f32_16x16x32_bf16 v[120:123], v[40:43], a[40:43], v[120:123]
    ds_read_b128 v[32:35], v0 offset:26624
    v_mfma_f32_16x16x32_bf16 v[120:123], v[44:47], a[32:35], v[120:123]
    ds_read_b128 v[36:39], v1 offset:26624
    s_waitcnt lgkmcnt(6)
    v_mfma_f32_16x16x32_bf16 v[48:51], v[8:11], a[48:51], v[48:51]
    v_mfma_f32_16x16x32_bf16 v[48:51], v[12:15], a[56:59], v[48:51]
    v_mfma_f32_16x16x32_bf16 v[52:55], v[12:15], a[60:63], v[52:55]
    ds_read_b128 v[40:43], v0 offset:28672
    v_mfma_f32_16x16x32_bf16 v[52:55], v[8:11], a[52:55], v[52:55]
    ds_read_b128 v[44:47], v1 offset:28672
    s_waitcnt lgkmcnt(6)
    v_mfma_f32_16x16x32_bf16 v[60:63], v[16:19], a[52:55], v[60:63]
    v_mfma_f32_16x16x32_bf16 v[60:63], v[20:23], a[60:63], v[60:63]
    v_mfma_f32_16x16x32_bf16 v[56:59], v[20:23], a[56:59], v[56:59]
    ds_read_b128 v[12:15], v0 offset:30720
    v_mfma_f32_16x16x32_bf16 v[56:59], v[16:19], a[48:51], v[56:59]
    ds_read_b128 v[8:11], v1 offset:30720
    s_waitcnt lgkmcnt(6)
    v_mfma_f32_16x16x32_bf16 v[64:67], v[24:27], a[48:51], v[64:67]
    v_mfma_f32_16x16x32_bf16 v[64:67], v[28:31], a[56:59], v[64:67]
    v_mfma_f32_16x16x32_bf16 v[68:71], v[28:31], a[60:63], v[68:71]
    ds_read_b128 v[20:23], v0 offset:32768
    v_mfma_f32_16x16x32_bf16 v[68:71], v[24:27], a[52:55], v[68:71]
    ds_read_b128 v[16:19], v1 offset:32768
    s_waitcnt lgkmcnt(6)
    v_mfma_f32_16x16x32_bf16 v[76:79], v[32:35], a[52:55], v[76:79]
    v_mfma_f32_16x16x32_bf16 v[76:79], v[36:39], a[60:63], v[76:79]
    v_mfma_f32_16x16x32_bf16 v[72:75], v[36:39], a[56:59], v[72:75]
    ds_read_b128 v[28:31], v0 offset:34816
    v_mfma_f32_16x16x32_bf16 v[72:75], v[32:35], a[48:51], v[72:75]
    ds_read_b128 v[24:27], v1 offset:34816
    s_waitcnt lgkmcnt(6)
    v_mfma_f32_16x16x32_bf16 v[80:83], v[40:43], a[48:51], v[80:83]
    v_mfma_f32_16x16x32_bf16 v[80:83], v[44:47], a[56:59], v[80:83]
    v_mfma_f32_16x16x32_bf16 v[84:87], v[44:47], a[60:63], v[84:87]
    ds_read_b128 v[36:39], v0 offset:36864
    v_mfma_f32_16x16x32_bf16 v[84:87], v[40:43], a[52:55], v[84:87]
    ds_read_b128 v[32:35], v1 offset:36864
    s_waitcnt lgkmcnt(6)
    v_mfma_f32_16x16x32_bf16 v[92:95], v[12:15], a[52:55], v[92:95]
    v_mfma_f32_16x16x32_bf16 v[92:95], v[8:11], a[60:63], v[92:95]
    v_mfma_f32_16x16x32_bf16 v[88:91], v[8:11], a[56:59], v[88:91]
    ds_read_b128 v[44:47], v0 offset:38912
    v_mfma_f32_16x16x32_bf16 v[88:91], v[12:15], a[48:51], v[88:91]
    ds_read_b128 v[40:43], v1 offset:38912
    s_waitcnt lgkmcnt(6)
    v_mfma_f32_16x16x32_bf16 v[96:99], v[20:23], a[48:51], v[96:99]
    v_mfma_f32_16x16x32_bf16 v[96:99], v[16:19], a[56:59], v[96:99]
    v_mfma_f32_16x16x32_bf16 v[100:103], v[16:19], a[60:63], v[100:103]
    v_mfma_f32_16x16x32_bf16 v[100:103], v[20:23], a[52:55], v[100:103]
    s_waitcnt lgkmcnt(4)
    v_mfma_f32_16x16x32_bf16 v[108:111], v[28:31], a[52:55], v[108:111]
    v_mfma_f32_16x16x32_bf16 v[108:111], v[24:27], a[60:63], v[108:111]
    v_mfma_f32_16x16x32_bf16 v[104:107], v[24:27], a[56:59], v[104:107]
    v_mfma_f32_16x16x32_bf16 v[104:107], v[28:31], a[48:51], v[104:107]
    s_waitcnt lgkmcnt(0)
    s_barrier
    ds_read_b128 a[64:67], v2 offset:32768
    ds_read_b128 v[8:11], v0 offset:40960
    ds_read_b128 a[72:75], v2 offset:34816
    ds_read_b128 v[12:15], v1 offset:40960
    v_mfma_f32_16x16x32_bf16 v[112:115], v[36:39], a[48:51], v[112:115]
    ds_read_b128 a[76:79], v2 offset:35840
    v_mfma_f32_16x16x32_bf16 v[112:115], v[32:35], a[56:59], v[112:115]
    ds_read_b128 a[68:71], v2 offset:33792
    v_mfma_f32_16x16x32_bf16 v[116:119], v[32:35], a[60:63], v[116:119]
    ds_read_b128 v[16:19], v0 offset:43008
    v_mfma_f32_16x16x32_bf16 v[116:119], v[36:39], a[52:55], v[116:119]
    ds_read_b128 v[20:23], v1 offset:43008
    v_mfma_f32_16x16x32_bf16 v[124:127], v[44:47], a[52:55], v[124:127]
    ds_read_b128 v[24:27], v0 offset:45056
    v_mfma_f32_16x16x32_bf16 v[124:127], v[40:43], a[60:63], v[124:127]
    ds_read_b128 v[28:31], v1 offset:45056
    v_mfma_f32_16x16x32_bf16 v[120:123], v[40:43], a[56:59], v[120:123]
    ds_read_b128 v[32:35], v0 offset:47104
    v_mfma_f32_16x16x32_bf16 v[120:123], v[44:47], a[48:51], v[120:123]
    ds_read_b128 v[36:39], v1 offset:47104
    s_waitcnt lgkmcnt(6)
    v_mfma_f32_16x16x32_bf16 v[48:51], v[8:11], a[64:67], v[48:51]
    v_mfma_f32_16x16x32_bf16 v[48:51], v[12:15], a[72:75], v[48:51]
    v_mfma_f32_16x16x32_bf16 v[52:55], v[12:15], a[76:79], v[52:55]
    ds_read_b128 v[40:43], v0 offset:49152
    v_mfma_f32_16x16x32_bf16 v[52:55], v[8:11], a[68:71], v[52:55]
    ds_read_b128 v[44:47], v1 offset:49152
    s_waitcnt lgkmcnt(6)
    v_mfma_f32_16x16x32_bf16 v[60:63], v[16:19], a[68:71], v[60:63]
    v_mfma_f32_16x16x32_bf16 v[60:63], v[20:23], a[76:79], v[60:63]
    v_mfma_f32_16x16x32_bf16 v[56:59], v[20:23], a[72:75], v[56:59]
    ds_read_b128 v[12:15], v0 offset:51200
    v_mfma_f32_16x16x32_bf16 v[56:59], v[16:19], a[64:67], v[56:59]
    ds_read_b128 v[8:11], v1 offset:51200
    s_waitcnt lgkmcnt(6)
    v_mfma_f32_16x16x32_bf16 v[64:67], v[24:27], a[64:67], v[64:67]
    v_mfma_f32_16x16x32_bf16 v[64:67], v[28:31], a[72:75], v[64:67]
    v_mfma_f32_16x16x32_bf16 v[68:71], v[28:31], a[76:79], v[68:71]
    ds_read_b128 v[20:23], v0 offset:53248
    v_mfma_f32_16x16x32_bf16 v[68:71], v[24:27], a[68:71], v[68:71]
    ds_read_b128 v[16:19], v1 offset:53248
    s_waitcnt lgkmcnt(6)
    v_mfma_f32_16x16x32_bf16 v[76:79], v[32:35], a[68:71], v[76:79]
    v_mfma_f32_16x16x32_bf16 v[76:79], v[36:39], a[76:79], v[76:79]
    v_mfma_f32_16x16x32_bf16 v[72:75], v[36:39], a[72:75], v[72:75]
    ds_read_b128 v[28:31], v0 offset:55296
    v_mfma_f32_16x16x32_bf16 v[72:75], v[32:35], a[64:67], v[72:75]
    ds_read_b128 v[24:27], v1 offset:55296
    s_waitcnt lgkmcnt(6)
    v_mfma_f32_16x16x32_bf16 v[80:83], v[40:43], a[64:67], v[80:83]
    v_mfma_f32_16x16x32_bf16 v[80:83], v[44:47], a[72:75], v[80:83]
    v_mfma_f32_16x16x32_bf16 v[84:87], v[44:47], a[76:79], v[84:87]
    ds_read_b128 v[36:39], v0 offset:57344
    v_mfma_f32_16x16x32_bf16 v[84:87], v[40:43], a[68:71], v[84:87]
    ds_read_b128 v[32:35], v1 offset:57344
    s_waitcnt lgkmcnt(6)
    v_mfma_f32_16x16x32_bf16 v[92:95], v[12:15], a[68:71], v[92:95]
    v_mfma_f32_16x16x32_bf16 v[92:95], v[8:11], a[76:79], v[92:95]
    v_mfma_f32_16x16x32_bf16 v[88:91], v[8:11], a[72:75], v[88:91]
    ds_read_b128 v[44:47], v0 offset:59392
    v_mfma_f32_16x16x32_bf16 v[88:91], v[12:15], a[64:67], v[88:91]
    ds_read_b128 v[40:43], v1 offset:59392
    s_waitcnt lgkmcnt(6)
    v_mfma_f32_16x16x32_bf16 v[96:99], v[20:23], a[64:67], v[96:99]
    v_mfma_f32_16x16x32_bf16 v[96:99], v[16:19], a[72:75], v[96:99]
    v_mfma_f32_16x16x32_bf16 v[100:103], v[16:19], a[76:79], v[100:103]
    v_mfma_f32_16x16x32_bf16 v[100:103], v[20:23], a[68:71], v[100:103]
    s_waitcnt lgkmcnt(4)
    v_mfma_f32_16x16x32_bf16 v[108:111], v[28:31], a[68:71], v[108:111]
    v_mfma_f32_16x16x32_bf16 v[108:111], v[24:27], a[76:79], v[108:111]
    v_mfma_f32_16x16x32_bf16 v[104:107], v[24:27], a[72:75], v[104:107]
    v_mfma_f32_16x16x32_bf16 v[104:107], v[28:31], a[64:67], v[104:107]
    s_waitcnt lgkmcnt(0)
    s_barrier
    ds_read_b128 a[80:83], v2 offset:49152
    ds_read_b128 v[8:11], v0 offset:0
    ds_read_b128 a[88:91], v2 offset:51200
    ds_read_b128 v[12:15], v1 offset:0
    v_mfma_f32_16x16x32_bf16 v[112:115], v[36:39], a[64:67], v[112:115]
    ds_read_b128 a[92:95], v2 offset:52224
    v_mfma_f32_16x16x32_bf16 v[112:115], v[32:35], a[72:75], v[112:115]
    ds_read_b128 a[84:87], v2 offset:50176
    v_mfma_f32_16x16x32_bf16 v[116:119], v[32:35], a[76:79], v[116:119]
    ds_read_b128 v[16:19], v0 offset:2048
    v_mfma_f32_16x16x32_bf16 v[116:119], v[36:39], a[68:71], v[116:119]
    ds_read_b128 v[20:23], v1 offset:2048
    v_mfma_f32_16x16x32_bf16 v[124:127], v[44:47], a[68:71], v[124:127]
    ds_read_b128 v[24:27], v0 offset:4096
    v_mfma_f32_16x16x32_bf16 v[124:127], v[40:43], a[76:79], v[124:127]
    ds_read_b128 v[28:31], v1 offset:4096
    v_mfma_f32_16x16x32_bf16 v[120:123], v[40:43], a[72:75], v[120:123]
    ds_read_b128 v[32:35], v0 offset:6144
    v_mfma_f32_16x16x32_bf16 v[120:123], v[44:47], a[64:67], v[120:123]
    ds_read_b128 v[36:39], v1 offset:6144
    s_waitcnt lgkmcnt(6)
    v_mfma_f32_16x16x32_bf16 v[48:51], v[8:11], a[80:83], v[48:51]
    v_mfma_f32_16x16x32_bf16 v[48:51], v[12:15], a[88:91], v[48:51]
    v_mfma_f32_16x16x32_bf16 v[52:55], v[12:15], a[92:95], v[52:55]
    ds_read_b128 v[40:43], v0 offset:8192
    v_mfma_f32_16x16x32_bf16 v[52:55], v[8:11], a[84:87], v[52:55]
    ds_read_b128 v[44:47], v1 offset:8192
    s_waitcnt lgkmcnt(6)
    v_mfma_f32_16x16x32_bf16 v[60:63], v[16:19], a[84:87], v[60:63]
    v_mfma_f32_16x16x32_bf16 v[60:63], v[20:23], a[92:95], v[60:63]
    v_mfma_f32_16x16x32_bf16 v[56:59], v[20:23], a[88:91], v[56:59]
    ds_read_b128 v[12:15], v0 offset:10240
    v_mfma_f32_16x16x32_bf16 v[56:59], v[16:19], a[80:83], v[56:59]
    ds_read_b128 v[8:11], v1 offset:10240
    s_waitcnt lgkmcnt(6)
    v_mfma_f32_16x16x32_bf16 v[64:67], v[24:27], a[80:83], v[64:67]
    v_mfma_f32_16x16x32_bf16 v[64:67], v[28:31], a[88:91], v[64:67]
    v_mfma_f32_16x16x32_bf16 v[68:71], v[28:31], a[92:95], v[68:71]
    ds_read_b128 v[20:23], v0 offset:12288
    v_mfma_f32_16x16x32_bf16 v[68:71], v[24:27], a[84:87], v[68:71]
    ds_read_b128 v[16:19], v1 offset:12288
    s_waitcnt lgkmcnt(6)
    v_mfma_f32_16x16x32_bf16 v[76:79], v[32:35], a[84:87], v[76:79]
    v_mfma_f32_16x16x32_bf16 v[76:79], v[36:39], a[92:95], v[76:79]
    v_mfma_f32_16x16x32_bf16 v[72:75], v[36:39], a[88:91], v[72:75]
    ds_read_b128 v[28:31], v0 offset:14336
    v_mfma_f32_16x16x32_bf16 v[72:75], v[32:35], a[80:83], v[72:75]
    ds_read_b128 v[24:27], v1 offset:14336
    s_waitcnt lgkmcnt(6)
    v_mfma_f32_16x16x32_bf16 v[80:83], v[40:43], a[80:83], v[80:83]
    v_mfma_f32_16x16x32_bf16 v[80:83], v[44:47], a[88:91], v[80:83]
    v_mfma_f32_16x16x32_bf16 v[84:87], v[44:47], a[92:95], v[84:87]
    ds_read_b128 v[36:39], v0 offset:16384
    v_mfma_f32_16x16x32_bf16 v[84:87], v[40:43], a[84:87], v[84:87]
    ds_read_b128 v[32:35], v1 offset:16384
    s_waitcnt lgkmcnt(6)
    v_mfma_f32_16x16x32_bf16 v[92:95], v[12:15], a[84:87], v[92:95]
    v_mfma_f32_16x16x32_bf16 v[92:95], v[8:11], a[92:95], v[92:95]
    v_mfma_f32_16x16x32_bf16 v[88:91], v[8:11], a[88:91], v[88:91]
    ds_read_b128 v[44:47], v0 offset:18432
    v_mfma_f32_16x16x32_bf16 v[88:91], v[12:15], a[80:83], v[88:91]
    ds_read_b128 v[40:43], v1 offset:18432
    s_waitcnt lgkmcnt(6)
    v_mfma_f32_16x16x32_bf16 v[96:99], v[20:23], a[80:83], v[96:99]
    v_mfma_f32_16x16x32_bf16 v[96:99], v[16:19], a[88:91], v[96:99]
    v_mfma_f32_16x16x32_bf16 v[100:103], v[16:19], a[92:95], v[100:103]
    v_mfma_f32_16x16x32_bf16 v[100:103], v[20:23], a[84:87], v[100:103]
    s_waitcnt lgkmcnt(4)
    v_mfma_f32_16x16x32_bf16 v[108:111], v[28:31], a[84:87], v[108:111]
    v_mfma_f32_16x16x32_bf16 v[108:111], v[24:27], a[92:95], v[108:111]
    v_mfma_f32_16x16x32_bf16 v[104:107], v[24:27], a[88:91], v[104:107]
    v_mfma_f32_16x16x32_bf16 v[104:107], v[28:31], a[80:83], v[104:107]
    s_waitcnt lgkmcnt(0)
    s_branch L_pg3
.p2align 12
L_stub3:
    s_branch L_warmed
L_pg3:
    s_barrier
    ds_read_b128 a[96:99], v2 offset:32768
    ds_read_b128 v[8:11], v0 offset:20480
    ds_read_b128 a[104:107], v2 offset:34816
    ds_read_b128 v[12:15], v1 offset:20480
    v_mfma_f32_16x16x32_bf16 v[112:115], v[36:39], a[80:83], v[112:115]
    ds_read_b128 a[108:111], v2 offset:35840
    v_mfma_f32_16x16x32_bf16 v[112:115], v[32:35], a[88:91], v[112:115]
    ds_read_b128 a[100:103], v2 offset:33792
    v_mfma_f32_16x16x32_bf16 v[116:119], v[32:35], a[92:95], v[116:119]
    ds_read_b128 v[16:19], v0 offset:22528
    v_mfma_f32_16x16x32_bf16 v[116:119], v[36:39], a[84:87], v[116:119]
    ds_read_b128 v[20:23], v1 offset:22528
    v_mfma_f32_16x16x32_bf16 v[124:127], v[44:47], a[84:87], v[124:127]
    ds_read_b128 v[24:27], v0 offset:24576
    v_mfma_f32_16x16x32_bf16 v[124:127], v[40:43], a[92:95], v[124:127]
    ds_read_b128 v[28:31], v1 offset:24576
    v_mfma_f32_16x16x32_bf16 v[120:123], v[40:43], a[88:91], v[120:123]
    ds_read_b128 v[32:35], v0 offset:26624
    v_mfma_f32_16x16x32_bf16 v[120:123], v[44:47], a[80:83], v[120:123]
    ds_read_b128 v[36:39], v1 offset:26624
    s_waitcnt lgkmcnt(6)
    v_mfma_f32_16x16x32_bf16 v[48:51], v[8:11], a[96:99], v[48:51]
    v_mfma_f32_16x16x32_bf16 v[48:51], v[12:15], a[104:107], v[48:51]
    v_mfma_f32_16x16x32_bf16 v[52:55], v[12:15], a[108:111], v[52:55]
    ds_read_b128 v[40:43], v0 offset:28672
    v_mfma_f32_16x16x32_bf16 v[52:55], v[8:11], a[100:103], v[52:55]
    ds_read_b128 v[44:47], v1 offset:28672
    s_waitcnt lgkmcnt(6)
    v_mfma_f32_16x16x32_bf16 v[60:63], v[16:19], a[100:103], v[60:63]
    v_mfma_f32_16x16x32_bf16 v[60:63], v[20:23], a[108:111], v[60:63]
    v_mfma_f32_16x16x32_bf16 v[56:59], v[20:23], a[104:107], v[56:59]
    ds_read_b128 v[12:15], v0 offset:30720
    v_mfma_f32_16x16x32_bf16 v[56:59], v[16:19], a[96:99], v[56:59]
    ds_read_b128 v[8:11], v1 offset:30720
    s_waitcnt lgkmcnt(6)
    v_mfma_f32_16x16x32_bf16 v[64:67], v[24:27], a[96:99], v[64:67]
    v_mfma_f32_16x16x32_bf16 v[64:67], v[28:31], a[104:107], v[64:67]
    v_mfma_f32_16x16x32_bf16 v[68:71], v[28:31], a[108:111], v[68:71]
    ds_read_b128 v[20:23], v0 offset:32768
    v_mfma_f32_16x16x32_bf16 v[68:71], v[24:27], a[100:103], v[68:71]
    ds_read_b128 v[16:19], v1 offset:32768
    s_waitcnt lgkmcnt(6)
    v_mfma_f32_16x16x32_bf16 v[76:79], v[32:35], a[100:103], v[76:79]
    v_mfma_f32_16x16x32_bf16 v[76:79], v[36:39], a[108:111], v[76:79]
    v_mfma_f32_16x16x32_bf16 v[72:75], v[36:39], a[104:107], v[72:75]
    ds_read_b128 v[28:31], v0 offset:34816
    v_mfma_f32_16x16x32_bf16 v[72:75], v[32:35], a[96:99], v[72:75]
    ds_read_b128 v[24:27], v1 offset:34816
    s_waitcnt lgkmcnt(6)
    v_mfma_f32_16x16x32_bf16 v[80:83], v[40:43], a[96:99], v[80:83]
    v_mfma_f32_16x16x32_bf16 v[80:83], v[44:47], a[104:107], v[80:83]
    v_mfma_f32_16x16x32_bf16 v[84:87], v[44:47], a[108:111], v[84:87]
    ds_read_b128 v[36:39], v0 offset:36864
    v_mfma_f32_16x16x32_bf16 v[84:87], v[40:43], a[100:103], v[84:87]
    ds_read_b128 v[32:35], v1 offset:36864
    s_waitcnt lgkmcnt(6)
    v_mfma_f32_16x16x32_bf16 v[92:95], v[12:15], a[100:103], v[92:95]
    v_mfma_f32_16x16x32_bf16 v[92:95], v[8:11], a[108:111], v[92:95]
    v_mfma_f32_16x16x32_bf16 v[88:91], v[8:11], a[104:107], v[88:91]
    ds_read_b128 v[44:47], v0 offset:38912
    v_mfma_f32_16x16x32_bf16 v[88:91], v[12:15], a[96:99], v[88:91]
    ds_read_b128 v[40:43], v1 offset:38912
    s_waitcnt lgkmcnt(6)
    v_mfma_f32_16x16x32_bf16 v[96:99], v[20:23], a[96:99], v[96:99]
    v_mfma_f32_16x16x32_bf16 v[96:99], v[16:19], a[104:107], v[96:99]
    v_mfma_f32_16x16x32_bf16 v[100:103], v[16:19], a[108:111], v[100:103]
    v_mfma_f32_16x16x32_bf16 v[100:103], v[20:23], a[100:103], v[100:103]
    s_waitcnt lgkmcnt(4)
    v_mfma_f32_16x16x32_bf16 v[108:111], v[28:31], a[100:103], v[108:111]
    v_mfma_f32_16x16x32_bf16 v[108:111], v[24:27], a[108:111], v[108:111]
    v_mfma_f32_16x16x32_bf16 v[104:107], v[24:27], a[104:107], v[104:107]
    v_mfma_f32_16x16x32_bf16 v[104:107], v[28:31], a[96:99], v[104:107]
    s_waitcnt lgkmcnt(0)
    s_barrier
    ds_read_b128 a[112:115], v2 offset:49152
    ds_read_b128 v[8:11], v0 offset:40960
    ds_read_b128 a[120:123], v2 offset:51200
    ds_read_b128 v[12:15], v1 offset:40960
    v_mfma_f32_16x16x32_bf16 v[112:115], v[36:39], a[96:99], v[112:115]
    ds_read_b128 a[124:127], v2 offset:52224
    v_mfma_f32_16x16x32_bf16 v[112:115], v[32:35], a[104:107], v[112:115]
    ds_read_b128 a[116:119], v2 offset:50176
    v_mfma_f32_16x16x32_bf16 v[116:119], v[32:35], a[108:111], v[116:119]
    ds_read_b128 v[16:19], v0 offset:43008
    v_mfma_f32_16x16x32_bf16 v[116:119], v[36:39], a[100:103], v[116:119]
    ds_read_b128 v[20:23], v1 offset:43008
    v_mfma_f32_16x16x32_bf16 v[124:127], v[44:47], a[100:103], v[124:127]
    ds_read_b128 v[24:27], v0 offset:45056
    v_mfma_f32_16x16x32_bf16 v[124:127], v[40:43], a[108:111], v[124:127]
    ds_read_b128 v[28:31], v1 offset:45056
    v_mfma_f32_16x16x32_bf16 v[120:123], v[40:43], a[104:107], v[120:123]
    ds_read_b128 v[32:35], v0 offset:47104
    v_mfma_f32_16x16x32_bf16 v[120:123], v[44:47], a[96:99], v[120:123]
    ds_read_b128 v[36:39], v1 offset:47104
    s_waitcnt lgkmcnt(6)
    v_mfma_f32_16x16x32_bf16 v[48:51], v[8:11], a[112:115], v[48:51]
    v_mfma_f32_16x16x32_bf16 v[48:51], v[12:15], a[120:123], v[48:51]
    v_mfma_f32_16x16x32_bf16 v[52:55], v[12:15], a[124:127], v[52:55]
    ds_read_b128 v[40:43], v0 offset:49152
    v_mfma_f32_16x16x32_bf16 v[52:55], v[8:11], a[116:119], v[52:55]
    ds_read_b128 v[44:47], v1 offset:49152
    s_waitcnt lgkmcnt(6)
    v_mfma_f32_16x16x32_bf16 v[60:63], v[16:19], a[116:119], v[60:63]
    s_add_u32 s55, s50, 0
    v_mfma_f32_16x16x32_bf16 v[60:63], v[20:23], a[124:127], v[60:63]
    v_mfma_f32_16x16x32_bf16 v[56:59], v[20:23], a[120:123], v[56:59]
    ds_read_b128 v[12:15], v0 offset:51200
    v_mfma_f32_16x16x32_bf16 v[56:59], v[16:19], a[112:115], v[56:59]
    ds_read_b128 v[8:11], v1 offset:51200
    v_cvt_pk_bf16_f32 v48, v48, v52
    s_waitcnt lgkmcnt(6)
    v_mfma_f32_16x16x32_bf16 v[64:67], v[24:27], a[112:115], v[64:67]
    v_cvt_pk_bf16_f32 v49, v49, v53
    v_mfma_f32_16x16x32_bf16 v[64:67], v[28:31], a[120:123], v[64:67]
    v_cvt_pk_bf16_f32 v50, v50, v54
    v_mfma_f32_16x16x32_bf16 v[68:71], v[28:31], a[124:127], v[68:71]
    ds_read_b128 v[20:23], v0 offset:53248
    v_cvt_pk_bf16_f32 v51, v51, v55
    v_mfma_f32_16x16x32_bf16 v[68:71], v[24:27], a[116:119], v[68:71]
    ds_read_b128 v[16:19], v1 offset:53248
    v_cvt_pk_bf16_f32 v56, v56, v60
    s_waitcnt lgkmcnt(6)
    v_mfma_f32_16x16x32_bf16 v[76:79], v[32:35], a[116:119], v[76:79]
    v_cvt_pk_bf16_f32 v57, v57, v61
    v_mfma_f32_16x16x32_bf16 v[76:79], v[36:39], a[124:127], v[76:79]
    v_cvt_pk_bf16_f32 v58, v58, v62
    v_mfma_f32_16x16x32_bf16 v[72:75], v[36:39], a[120:123], v[72:75]
    ds_read_b128 v[28:31], v0 offset:55296
    v_cvt_pk_bf16_f32 v59, v59, v63
    v_mfma_f32_16x16x32_bf16 v[72:75], v[32:35], a[112:115], v[72:75]
    ds_read_b128 v[52:55], v1 offset:55296
    v_cvt_pk_bf16_f32 v64, v64, v68
    s_waitcnt lgkmcnt(6)
    v_mfma_f32_16x16x32_bf16 v[80:83], v[40:43], a[112:115], v[80:83]
    v_cvt_pk_bf16_f32 v65, v65, v69
    v_mfma_f32_16x16x32_bf16 v[80:83], v[44:47], a[120:123], v[80:83]
    v_cvt_pk_bf16_f32 v66, v66, v70
    v_mfma_f32_16x16x32_bf16 v[84:87], v[44:47], a[124:127], v[84:87]
    ds_read_b128 v[24:27], v0 offset:57344
    v_cvt_pk_bf16_f32 v67, v67, v71
    v_mfma_f32_16x16x32_bf16 v[84:87], v[40:43], a[116:119], v[84:87]
    ds_read_b128 v[36:39], v1 offset:57344
    v_cvt_pk_bf16_f32 v72, v72, v76
    s_waitcnt lgkmcnt(6)
    v_mfma_f32_16x16x32_bf16 v[92:95], v[12:15], a[116:119], v[92:95]
    v_cvt_pk_bf16_f32 v73, v73, v77
    v_mfma_f32_16x16x32_bf16 v[92:95], v[8:11], a[124:127], v[92:95]
    v_cvt_pk_bf16_f32 v74, v74, v78
    v_mfma_f32_16x16x32_bf16 v[88:91], v[8:11], a[120:123], v[88:91]
    ds_read_b128 v[60:63], v0 offset:59392
    v_cvt_pk_bf16_f32 v75, v75, v79
    v_mfma_f32_16x16x32_bf16 v[88:91], v[12:15], a[112:115], v[88:91]
    ds_read_b128 v[32:35], v1 offset:59392
    v_cvt_pk_bf16_f32 v80, v80, v84
    s_waitcnt lgkmcnt(6)
    v_mfma_f32_16x16x32_bf16 v[96:99], v[20:23], a[112:115], v[96:99]
    v_cvt_pk_bf16_f32 v81, v81, v85
    v_mfma_f32_16x16x32_bf16 v[96:99], v[16:19], a[120:123], v[96:99]
    v_cvt_pk_bf16_f32 v82, v82, v86
    v_mfma_f32_16x16x32_bf16 v[100:103], v[16:19], a[124:127], v[100:103]
    v_cvt_pk_bf16_f32 v83, v83, v87
    v_mfma_f32_16x16x32_bf16 v[100:103], v[20:23], a[116:119], v[100:103]
    v_cvt_pk_bf16_f32 v88, v88, v92
    s_waitcnt lgkmcnt(4)
    v_mfma_f32_16x16x32_bf16 v[108:111], v[28:31], a[116:119], v[108:111]
    v_cvt_pk_bf16_f32 v89, v89, v93
    v_mfma_f32_16x16x32_bf16 v[108:111], v[52:55], a[124:127], v[108:111]
    v_cvt_pk_bf16_f32 v90, v90, v94
    v_mfma_f32_16x16x32_bf16 v[104:107], v[52:55], a[120:123], v[104:107]
    v_cvt_pk_bf16_f32 v91, v91, v95
    v_mfma_f32_16x16x32_bf16 v[104:107], v[28:31], a[112:115], v[104:107]
    v_cvt_pk_bf16_f32 v96, v96, v100
    s_waitcnt lgkmcnt(0)
    s_barrier
L_c2:
    v_add_u32 v0, 0xffff7000, v0
    ds_read_b128 v[44:47], v0 offset:0
    v_add_u32 v1, 0xffff7000, v1
    ds_read_b128 v[68:71], v1 offset:0
    ds_read_b128 v[40:43], v0 offset:2048
    ds_read_b128 v[8:11], v1 offset:2048
    v_mfma_f32_16x16x32_bf16 v[112:115], v[24:27], a[112:115], v[112:115]
    v_cvt_pk_bf16_f32 v97, v97, v101
    v_mfma_f32_16x16x32_bf16 v[112:115], v[36:39], a[120:123], v[112:115]
    v_cvt_pk_bf16_f32 v98, v98, v102
    v_mfma_f32_16x16x32_bf16 v[116:119], v[36:39], a[124:127], v[116:119]
    ds_read_b128 v[76:79], v0 offset:4096
    v_cvt_pk_bf16_f32 v99, v99, v103
    v_mfma_f32_16x16x32_bf16 v[116:119], v[24:27], a[116:119], v[116:119]
    ds_read_b128 v[12:15], v1 offset:4096
    v_cvt_pk_bf16_f32 v104, v104, v108
    v_mfma_f32_16x16x32_bf16 v[124:127], v[60:63], a[116:119], v[124:127]
    ds_read_b128 v[16:19], v0 offset:6144
    v_cvt_pk_bf16_f32 v105, v105, v109
    v_mfma_f32_16x16x32_bf16 v[124:127], v[32:35], a[124:127], v[124:127]
    ds_read_b128 v[84:87], v1 offset:6144
    v_cvt_pk_bf16_f32 v106, v106, v110
    v_mfma_f32_16x16x32_bf16 v[120:123], v[32:35], a[120:123], v[120:123]
    v_cvt_pk_bf16_f32 v107, v107, v111
    v_mfma_f32_16x16x32_bf16 v[120:123], v[60:63], a[112:115], v[120:123]
    v_cvt_pk_bf16_f32 v112, v112, v116
    s_waitcnt lgkmcnt(4)
    v_mfma_f32_16x16x32_bf16 v[20:23], v[44:47], a[0:3], 0
    v_cvt_pk_bf16_f32 v113, v113, v117
    v_mfma_f32_16x16x32_bf16 v[20:23], v[68:71], a[8:11], v[20:23]
    v_cvt_pk_bf16_f32 v114, v114, v118
    v_mfma_f32_16x16x32_bf16 v[20:23], v[40:43], a[16:19], v[20:23]
    ds_read_b128 v[52:55], v0 offset:8192
    v_cvt_pk_bf16_f32 v115, v115, v119
    v_mfma_f32_16x16x32_bf16 v[20:23], v[8:11], a[24:27], v[20:23]
    v_cvt_pk_bf16_f32 v120, v120, v124
    v_mfma_f32_16x16x32_bf16 v[92:95], v[8:11], a[28:31], 0
    ds_read_b128 v[28:31], v1 offset:8192
    v_cvt_pk_bf16_f32 v121, v121, v125
    v_mfma_f32_16x16x32_bf16 v[92:95], v[40:43], a[20:23], v[92:95]
    v_cvt_pk_bf16_f32 v122, v122, v126
    v_mfma_f32_16x16x32_bf16 v[92:95], v[68:71], a[12:15], v[92:95]
    ds_read_b128 v[36:39], v0 offset:10240
    v_cvt_pk_bf16_f32 v123, v123, v127
    v_mfma_f32_16x16x32_bf16 v[92:95], v[44:47], a[4:7], v[92:95]
    s_waitcnt lgkmcnt(3)
    v_mfma_f32_16x16x32_bf16 v[92:95], v[76:79], a[36:39], v[92:95]
    ds_read_b128 v[100:103], v1 offset:10240
    v_mfma_f32_16x16x32_bf16 v[92:95], v[12:15], a[44:47], v[92:95]
    v_mfma_f32_16x16x32_bf16 v[92:95], v[16:19], a[52:55], v[92:95]
    ds_read_b128 v[24:27], v0 offset:12288
    v_mfma_f32_16x16x32_bf16 v[92:95], v[84:87], a[60:63], v[92:95]
    v_mfma_f32_16x16x32_bf16 v[20:23], v[84:87], a[56:59], v[20:23]
    ds_read_b128 v[32:35], v1 offset:12288
    v_mfma_f32_16x16x32_bf16 v[20:23], v[16:19], a[48:51], v[20:23]
    v_mfma_f32_16x16x32_bf16 v[20:23], v[12:15], a[40:43], v[20:23]
    ds_read_b128 v[108:111], v0 offset:14336
    v_mfma_f32_16x16x32_bf16 v[20:23], v[76:79], a[32:35], v[20:23]
    s_barrier
    s_waitcnt lgkmcnt(3)
    v_mfma_f32_16x16x32_bf16 v[20:23], v[52:55], a[64:67], v[20:23]
    ds_read_b128 v[60:63], v1 offset:14336
    v_mfma_f32_16x16x32_bf16 v[20:23], v[28:31], a[72:75], v[20:23]
    v_mfma_f32_16x16x32_bf16 v[20:23], v[36:39], a[80:83], v[20:23]
    ds_read_b128 v[116:119], v0 offset:16384
    v_mfma_f32_16x16x32_bf16 v[20:23], v[100:103], a[88:91], v[20:23]
    v_mfma_f32_16x16x32_bf16 v[92:95], v[100:103], a[92:95], v[92:95]
    ds_read_b128 v[8:11], v1 offset:16384
    v_mfma_f32_16x16x32_bf16 v[92:95], v[36:39], a[84:87], v[92:95]
    v_mfma_f32_16x16x32_bf16 v[92:95], v[28:31], a[76:79], v[92:95]
    ds_read_b128 v[40:43], v0 offset:18432
    v_mfma_f32_16x16x32_bf16 v[92:95], v[52:55], a[68:71], v[92:95]
    s_waitcnt lgkmcnt(3)
    v_mfma_f32_16x16x32_bf16 v[92:95], v[24:27], a[100:103], v[92:95]
    ds_read_b128 v[68:71], v1 offset:18432
    v_mfma_f32_16x16x32_bf16 v[92:95], v[32:35], a[108:111], v[92:95]
    v_mfma_f32_16x16x32_bf16 v[92:95], v[108:111], a[116:119], v[92:95]
    ds_read_b128 v[124:127], v0 offset:20480
    v_mfma_f32_16x16x32_bf16 v[92:95], v[60:63], a[124:127], v[92:95]
    v_mfma_f32_16x16x32_bf16 v[20:23], v[60:63], a[120:123], v[20:23]
    ds_read_b128 v[44:47], v1 offset:20480
    v_mfma_f32_16x16x32_bf16 v[20:23], v[108:111], a[112:115], v[20:23]
    v_mfma_f32_16x16x32_bf16 v[20:23], v[32:35], a[104:107], v[20:23]
    ds_read_b128 v[84:87], v0 offset:22528
    v_mfma_f32_16x16x32_bf16 v[20:23], v[24:27], a[96:99], v[20:23]
    s_waitcnt lgkmcnt(3)
    v_mfma_f32_16x16x32_bf16 v[16:19], v[116:119], a[0:3], 0
    ds_read_b128 v[12:15], v1 offset:22528
    v_mfma_f32_16x16x32_bf16 v[16:19], v[8:11], a[8:11], v[16:19]
    v_mfma_f32_16x16x32_bf16 v[16:19], v[40:43], a[16:19], v[16:19]
    ds_read_b128 v[76:79], v0 offset:24576
    v_mfma_f32_16x16x32_bf16 v[16:19], v[68:71], a[24:27], v[16:19]
    v_mfma_f32_16x16x32_bf16 v[100:103], v[68:71], a[28:31], 0
    ds_read_b128 v[36:39], v1 offset:24576
    v_cvt_pk_bf16_f32 v20, v20, v92
    v_mfma_f32_16x16x32_bf16 v[100:103], v[40:43], a[20:23], v[100:103]
    v_cvt_pk_bf16_f32 v21, v21, v93
    v_mfma_f32_16x16x32_bf16 v[100:103], v[8:11], a[12:15], v[100:103]
    ds_read_b128 v[28:31], v0 offset:26624
    v_cvt_pk_bf16_f32 v22, v22, v94
    v_mfma_f32_16x16x32_bf16 v[100:103], v[116:119], a[4:7], v[100:103]
    v_cvt_pk_bf16_f32 v23, v23, v95
    s_waitcnt lgkmcnt(3)
    v_mfma_f32_16x16x32_bf16 v[100:103], v[124:127], a[36:39], v[100:103]
    ds_read_b128 v[52:55], v1 offset:26624
    v_mfma_f32_16x16x32_bf16 v[100:103], v[44:47], a[44:47], v[100:103]
    v_mfma_f32_16x16x32_bf16 v[100:103], v[84:87], a[52:55], v[100:103]
    ds_read_b128 v[60:63], v0 offset:28672
    v_mfma_f32_16x16x32_bf16 v[100:103], v[12:15], a[60:63], v[100:103]
    v_mfma_f32_16x16x32_bf16 v[16:19], v[12:15], a[56:59], v[16:19]
    ds_read_b128 v[108:111], v1 offset:28672
    v_mfma_f32_16x16x32_bf16 v[16:19], v[84:87], a[48:51], v[16:19]
    v_mfma_f32_16x16x32_bf16 v[16:19], v[44:47], a[40:43], v[16:19]
    ds_read_b128 v[32:35], v0 offset:30720
    v_mfma_f32_16x16x32_bf16 v[16:19], v[124:127], a[32:35], v[16:19]
    s_barrier
    s_waitcnt lgkmcnt(3)
    v_mfma_f32_16x16x32_bf16 v[16:19], v[76:79], a[64:67], v[16:19]
    ds_read_b128 v[24:27], v1 offset:30720
    v_mfma_f32_16x16x32_bf16 v[16:19], v[36:39], a[72:75], v[16:19]
    v_mfma_f32_16x16x32_bf16 v[16:19], v[28:31], a[80:83], v[16:19]
    ds_read_b128 v[68:71], v0 offset:32768
    v_mfma_f32_16x16x32_bf16 v[16:19], v[52:55], a[88:91], v[16:19]
    v_mfma_f32_16x16x32_bf16 v[100:103], v[52:55], a[92:95], v[100:103]
    ds_read_b128 v[40:43], v1 offset:32768
    v_mfma_f32_16x16x32_bf16 v[100:103], v[28:31], a[84:87], v[100:103]
    v_mfma_f32_16x16x32_bf16 v[100:103], v[36:39], a[76:79], v[100:103]
    ds_read_b128 v[8:11], v0 offset:34816
    v_mfma_f32_16x16x32_bf16 v[100:103], v[76:79], a[68:71], v[100:103]
    s_waitcnt lgkmcnt(3)
    v_mfma_f32_16x16x32_bf16 v[100:103], v[60:63], a[100:103], v[100:103]
    ds_read_b128 v[116:119], v1 offset:34816
    v_mfma_f32_16x16x32_bf16 v[100:103], v[108:111], a[108:111], v[100:103]
    v_mfma_f32_16x16x32_bf16 v[100:103], v[32:35], a[116:119], v[100:103]
    ds_read_b128 v[92:95], v0 offset:36864
    v_mfma_f32_16x16x32_bf16 v[100:103], v[24:27], a[124:127], v[100:103]
    v_mfma_f32_16x16x32_bf16 v[16:19], v[24:27], a[120:123], v[16:19]
    ds_read_b128 v[12:15], v1 offset:36864
    v_mfma_f32_16x16x32_bf16 v[16:19], v[32:35], a[112:115], v[16:19]
    v_mfma_f32_16x16x32_bf16 v[16:19], v[108:111], a[104:107], v[16:19]
    ds_read_b128 v[84:87], v0 offset:38912
    v_mfma_f32_16x16x32_bf16 v[16:19], v[60:63], a[96:99], v[16:19]
    s_waitcnt lgkmcnt(3)
    v_mfma_f32_16x16x32_bf16 v[44:47], v[68:71], a[0:3], 0
    ds_read_b128 v[124:127], v1 offset:38912
    v_mfma_f32_16x16x32_bf16 v[44:47], v[40:43], a[8:11], v[44:47]
    buffer_store_dword v48, v4, s[28:31], s55 offen nt
    v_mfma_f32_16x16x32_bf16 v[44:47], v[8:11], a[16:19], v[44:47]
    ds_read_b128 v[52:55], v0 offset:40960
    v_mfma_f32_16x16x32_bf16 v[44:47], v[116:119], a[24:27], v[44:47]
    buffer_store_dword v49, v5, s[28:31], s55 offen nt
    v_mfma_f32_16x16x32_bf16 v[28:31], v[116:119], a[28:31], 0
    ds_read_b128 v[36:39], v1 offset:40960
    v_cvt_pk_bf16_f32 v16, v16, v100
    v_mfma_f32_16x16x32_bf16 v[28:31], v[8:11], a[20:23], v[28:31]
    buffer_store_dword v50, v6, s[28:31], s55 offen nt
    v_mfma_f32_16x16x32_bf16 v[28:31], v[40:43], a[12:15], v[28:31]
    ds_read_b128 v[76:79], v0 offset:43008
    v_cvt_pk_bf16_f32 v17, v17, v101
    v_mfma_f32_16x16x32_bf16 v[28:31], v[68:71], a[4:7], v[28:31]
    v_cvt_pk_bf16_f32 v18, v18, v102
    s_waitcnt lgkmcnt(3)
    v_mfma_f32_16x16x32_bf16 v[28:31], v[92:95], a[36:39], v[28:31]
    ds_read_b128 v[24:27], v1 offset:43008
    v_cvt_pk_bf16_f32 v19, v19, v103
    v_mfma_f32_16x16x32_bf16 v[28:31], v[12:15], a[44:47], v[28:31]
    buffer_store_dword v51, v7, s[28:31], s55 offen nt
    v_mfma_f32_16x16x32_bf16 v[28:31], v[84:87], a[52:55], v[28:31]
    ds_read_b128 v[32:35], v0 offset:45056
    v_mfma_f32_16x16x32_bf16 v[28:31], v[124:127], a[60:63], v[28:31]
    s_add_u32 s55, s50, 147456
    v_mfma_f32_16x16x32_bf16 v[44:47], v[124:127], a[56:59], v[44:47]
    ds_read_b128 v[108:111], v1 offset:45056
    v_mfma_f32_16x16x32_bf16 v[44:47], v[84:87], a[48:51], v[44:47]
    buffer_store_dword v56, v4, s[28:31], s55 offen nt
    v_mfma_f32_16x16x32_bf16 v[44:47], v[12:15], a[40:43], v[44:47]
    ds_read_b128 v[60:63], v0 offset:47104
    v_mfma_f32_16x16x32_bf16 v[44:47], v[92:95], a[32:35], v[44:47]
    s_branch L_pg4
.p2align 12
L_stub4:
    s_branch L_warmed
L_pg4:
    s_barrier
    s_waitcnt lgkmcnt(3)
    v_mfma_f32_16x16x32_bf16 v[44:47], v[52:55], a[64:67], v[44:47]
    ds_read_b128 v[116:119], v1 offset:47104
    v_mfma_f32_16x16x32_bf16 v[44:47], v[36:39], a[72:75], v[44:47]
    buffer_store_dword v57, v5, s[28:31], s55 offen nt
    v_mfma_f32_16x16x32_bf16 v[44:47], v[76:79], a[80:83], v[44:47]
    ds_read_b128 v[8:11], v0 offset:49152
    v_mfma_f32_16x16x32_bf16 v[44:47], v[24:27], a[88:91], v[44:47]
    buffer_store_dword v58, v6, s[28:31], s55 offen nt
    v_mfma_f32_16x16x32_bf16 v[28:31], v[24:27], a[92:95], v[28:31]
    ds_read_b128 v[40:43], v1 offset:49152
    v_mfma_f32_16x16x32_bf16 v[28:31], v[76:79], a[84:87], v[28:31]
    buffer_store_dword v59, v7, s[28:31], s55 offen nt
    v_mfma_f32_16x16x32_bf16 v[28:31], v[36:39], a[76:79], v[28:31]
    ds_read_b128 v[68:71], v0 offset:51200
    v_mfma_f32_16x16x32_bf16 v[28:31], v[52:55], a[68:71], v[28:31]
    s_add_u32 s55, s50, 294912
    s_waitcnt lgkmcnt(3)
    v_mfma_f32_16x16x32_bf16 v[28:31], v[32:35], a[100:103], v[28:31]
    ds_read_b128 v[100:103], v1 offset:51200
    v_mfma_f32_16x16x32_bf16 v[28:31], v[108:111], a[108:111], v[28:31]
    buffer_store_dword v64, v4, s[28:31], s55 offen nt
    v_mfma_f32_16x16x32_bf16 v[28:31], v[60:63], a[116:119], v[28:31]
    ds_read_b128 v[48:51], v0 offset:53248
    v_mfma_f32_16x16x32_bf16 v[28:31], v[116:119], a[124:127], v[28:31]
    buffer_store_dword v65, v5, s[28:31], s55 offen nt
    v_mfma_f32_16x16x32_bf16 v[44:47], v[116:119], a[120:123], v[44:47]
    ds_read_b128 v[124:127], v1 offset:53248
    v_mfma_f32_16x16x32_bf16 v[44:47], v[60:63], a[112:115], v[44:47]
    buffer_store_dword v66, v6, s[28:31], s55 offen nt
    v_mfma_f32_16x16x32_bf16 v[44:47], v[108:111], a[104:107], v[44:47]
    ds_read_b128 v[84:87], v0 offset:55296
    v_mfma_f32_16x16x32_bf16 v[44:47], v[32:35], a[96:99], v[44:47]
    s_waitcnt lgkmcnt(3)
    v_mfma_f32_16x16x32_bf16 v[12:15], v[8:11], a[0:3], 0
    ds_read_b128 v[92:95], v1 offset:55296
    v_mfma_f32_16x16x32_bf16 v[12:15], v[40:43], a[8:11], v[12:15]
    buffer_store_dword v67, v7, s[28:31], s55 offen nt
    v_mfma_f32_16x16x32_bf16 v[12:15], v[68:71], a[16:19], v[12:15]
    ds_read_b128 v[24:27], v0 offset:57344
    v_mfma_f32_16x16x32_bf16 v[12:15], v[100:103], a[24:27], v[12:15]
    s_add_u32 s55, s50, 442368
    v_mfma_f32_16x16x32_bf16 v[76:79], v[100:103], a[28:31], 0
    ds_read_b128 v[36:39], v1 offset:57344
    v_cvt_pk_bf16_f32 v44, v44, v28
    v_mfma_f32_16x16x32_bf16 v[76:79], v[68:71], a[20:23], v[76:79]
    buffer_store_dword v72, v4, s[28:31], s55 offen nt
    v_mfma_f32_16x16x32_bf16 v[76:79], v[40:43], a[12:15], v[76:79]
    ds_read_b128 v[56:59], v0 offset:59392
    v_cvt_pk_bf16_f32 v45, v45, v29
    v_mfma_f32_16x16x32_bf16 v[76:79], v[8:11], a[4:7], v[76:79]
    v_cvt_pk_bf16_f32 v46, v46, v30
    s_waitcnt lgkmcnt(3)
    v_mfma_f32_16x16x32_bf16 v[76:79], v[48:51], a[36:39], v[76:79]
    ds_read_b128 v[52:55], v1 offset:59392
    v_cvt_pk_bf16_f32 v47, v47, v31
    v_mfma_f32_16x16x32_bf16 v[76:79], v[124:127], a[44:47], v[76:79]
    buffer_store_dword v73, v5, s[28:31], s55 offen nt
    v_mfma_f32_16x16x32_bf16 v[76:79], v[84:87], a[52:55], v[76:79]
    ds_read_b128 v[116:119], v0 offset:61440
    v_mfma_f32_16x16x32_bf16 v[76:79], v[92:95], a[60:63], v[76:79]
    buffer_store_dword v74, v6, s[28:31], s55 offen nt
    v_mfma_f32_16x16x32_bf16 v[12:15], v[92:95], a[56:59], v[12:15]
    ds_read_b128 v[60:63], v1 offset:61440
    v_mfma_f32_16x16x32_bf16 v[12:15], v[84:87], a[48:51], v[12:15]
    buffer_store_dword v75, v7, s[28:31], s55 offen nt
    v_mfma_f32_16x16x32_bf16 v[12:15], v[124:127], a[40:43], v[12:15]
    ds_read_b128 v[108:111], v0 offset:63488
    v_mfma_f32_16x16x32_bf16 v[12:15], v[48:51], a[32:35], v[12:15]
    s_add_u32 s55, s50, 589824
    s_barrier
    s_waitcnt lgkmcnt(3)
    v_mfma_f32_16x16x32_bf16 v[12:15], v[24:27], a[64:67], v[12:15]
    ds_read_b128 v[32:35], v1 offset:63488
    v_mfma_f32_16x16x32_bf16 v[12:15], v[36:39], a[72:75], v[12:15]
    buffer_store_dword v80, v4, s[28:31], s55 offen nt
    v_mfma_f32_16x16x32_bf16 v[12:15], v[56:59], a[80:83], v[12:15]
    v_add_u32 v0, 0xffff0000, v0
    ds_read_b128 v[64:67], v0 offset:0
    v_mfma_f32_16x16x32_bf16 v[12:15], v[52:55], a[88:91], v[12:15]
    buffer_store_dword v81, v5, s[28:31], s55 offen nt
    v_mfma_f32_16x16x32_bf16 v[76:79], v[52:55], a[92:95], v[76:79]
    v_add_u32 v1, 0xffff0000, v1
    ds_read_b128 v[100:103], v1 offset:0
    v_mfma_f32_16x16x32_bf16 v[76:79], v[56:59], a[84:87], v[76:79]
    buffer_store_dword v82, v6, s[28:31], s55 offen nt
    v_mfma_f32_16x16x32_bf16 v[76:79], v[36:39], a[76:79], v[76:79]
    ds_read_b128 v[68:71], v0 offset:2048
    v_mfma_f32_16x16x32_bf16 v[76:79], v[24:27], a[68:71], v[76:79]
    s_waitcnt lgkmcnt(3)
    v_mfma_f32_16x16x32_bf16 v[76:79], v[116:119], a[100:103], v[76:79]
    ds_read_b128 v[40:43], v1 offset:2048
    v_mfma_f32_16x16x32_bf16 v[76:79], v[60:63], a[108:111], v[76:79]
    buffer_store_dword v83, v7, s[28:31], s55 offen nt
    v_mfma_f32_16x16x32_bf16 v[76:79], v[108:111], a[116:119], v[76:79]
    ds_read_b128 v[8:11], v0 offset:4096
    v_mfma_f32_16x16x32_bf16 v[76:79], v[32:35], a[124:127], v[76:79]
    s_add_u32 s55, s50, 737280
    v_mfma_f32_16x16x32_bf16 v[12:15], v[32:35], a[120:123], v[12:15]
    ds_read_b128 v[28:31], v1 offset:4096
    v_mfma_f32_16x16x32_bf16 v[12:15], v[108:111], a[112:115], v[12:15]
    buffer_store_dword v88, v4, s[28:31], s55 offen nt
    v_mfma_f32_16x16x32_bf16 v[12:15], v[60:63], a[104:107], v[12:15]
    ds_read_b128 v[92:95], v0 offset:6144
    v_mfma_f32_16x16x32_bf16 v[12:15], v[116:119], a[96:99], v[12:15]
    s_waitcnt lgkmcnt(3)
    v_mfma_f32_16x16x32_bf16 v[84:87], v[64:67], a[0:3], 0
    ds_read_b128 v[124:127], v1 offset:6144
    v_mfma_f32_16x16x32_bf16 v[84:87], v[100:103], a[8:11], v[84:87]
    buffer_store_dword v89, v5, s[28:31], s55 offen nt
    v_mfma_f32_16x16x32_bf16 v[84:87], v[68:71], a[16:19], v[84:87]
    ds_read_b128 v[72:75], v0 offset:8192
    v_mfma_f32_16x16x32_bf16 v[84:87], v[40:43], a[24:27], v[84:87]
    buffer_store_dword v90, v6, s[28:31], s55 offen nt
    v_mfma_f32_16x16x32_bf16 v[48:51], v[40:43], a[28:31], 0
    ds_read_b128 v[52:55], v1 offset:8192
    v_cvt_pk_bf16_f32 v12, v12, v76
    v_mfma_f32_16x16x32_bf16 v[48:51], v[68:71], a[20:23], v[48:51]
    buffer_store_dword v91, v7, s[28:31], s55 offen nt
    v_mfma_f32_16x16x32_bf16 v[48:51], v[100:103], a[12:15], v[48:51]
    ds_read_b128 v[56:59], v0 offset:10240
    v_cvt_pk_bf16_f32 v13, v13, v77
    v_mfma_f32_16x16x32_bf16 v[48:51], v[64:67], a[4:7], v[48:51]
    s_add_u32 s55, s50, 884736
    s_waitcnt lgkmcnt(3)
    v_mfma_f32_16x16x32_bf16 v[48:51], v[8:11], a[36:39], v[48:51]
    ds_read_b128 v[36:39], v1 offset:10240
    v_cvt_pk_bf16_f32 v14, v14, v78
    v_mfma_f32_16x16x32_bf16 v[48:51], v[28:31], a[44:47], v[48:51]
    buffer_store_dword v96, v4, s[28:31], s55 offen nt
    v_mfma_f32_16x16x32_bf16 v[48:51], v[92:95], a[52:55], v[48:51]
    ds_read_b128 v[24:27], v0 offset:12288
    v_cvt_pk_bf16_f32 v15, v15, v79
    v_mfma_f32_16x16x32_bf16 v[48:51], v[124:127], a[60:63], v[48:51]
    buffer_store_dword v97, v5, s[28:31], s55 offen nt
    v_mfma_f32_16x16x32_bf16 v[84:87], v[124:127], a[56:59], v[84:87]
    ds_read_b128 v[80:83], v1 offset:12288
    v_mfma_f32_16x16x32_bf16 v[84:87], v[92:95], a[48:51], v[84:87]
    buffer_store_dword v98, v6, s[28:31], s55 offen nt
    v_mfma_f32_16x16x32_bf16 v[84:87], v[28:31], a[40:43], v[84:87]
    ds_read_b128 v[32:35], v0 offset:14336
    v_mfma_f32_16x16x32_bf16 v[84:87], v[8:11], a[32:35], v[84:87]
    s_barrier
    s_waitcnt lgkmcnt(3)
    v_mfma_f32_16x16x32_bf16 v[84:87], v[72:75], a[64:67], v[84:87]
    ds_read_b128 v[108:111], v1 offset:14336
    v_mfma_f32_16x16x32_bf16 v[84:87], v[52:55], a[72:75], v[84:87]
    buffer_store_dword v99, v7, s[28:31], s55 offen nt
    v_mfma_f32_16x16x32_bf16 v[84:87], v[56:59], a[80:83], v[84:87]
    ds_read_b128 v[60:63], v0 offset:32768
    v_mfma_f32_16x16x32_bf16 v[84:87], v[36:39], a[88:91], v[84:87]
    s_add_u32 s55, s50, 1032192
    v_mfma_f32_16x16x32_bf16 v[48:51], v[36:39], a[92:95], v[48:51]
    ds_read_b128 v[116:119], v1 offset:32768
    v_mfma_f32_16x16x32_bf16 v[48:51], v[56:59], a[84:87], v[48:51]
    buffer_store_dword v104, v4, s[28:31], s55 offen nt
    v_mfma_f32_16x16x32_bf16 v[48:51], v[52:55], a[76:79], v[48:51]
    ds_read_b128 v[40:43], v0 offset:34816
    v_mfma_f32_16x16x32_bf16 v[48:51], v[72:75], a[68:71], v[48:51]
    s_waitcnt lgkmcnt(3)
    v_mfma_f32_16x16x32_bf16 v[48:51], v[24:27], a[100:103], v[48:51]
    ds_read_b128 v[68:71], v1 offset:34816
    v_mfma_f32_16x16x32_bf16 v[48:51], v[80:83], a[108:111], v[48:51]
    buffer_store_dword v105, v5, s[28:31], s55 offen nt
    v_mfma_f32_16x16x32_bf16 v[48:51], v[32:35], a[116:119], v[48:51]
    ds_read_b128 v[100:103], v0 offset:36864
    v_mfma_f32_16x16x32_bf16 v[48:51], v[108:111], a[124:127], v[48:51]
    buffer_store_dword v106, v6, s[28:31], s55 offen nt
    v_mfma_f32_16x16x32_bf16 v[84:87], v[108:111], a[120:123], v[84:87]
    ds_read_b128 v[88:91], v1 offset:36864
    v_mfma_f32_16x16x32_bf16 v[84:87], v[32:35], a[112:115], v[84:87]
    buffer_store_dword v107, v7, s[28:31], s55 offen nt
    v_mfma_f32_16x16x32_bf16 v[84:87], v[80:83], a[104:107], v[84:87]
    ds_read_b128 v[64:67], v0 offset:38912
    v_mfma_f32_16x16x32_bf16 v[84:87], v[24:27], a[96:99], v[84:87]
    s_add_u32 s55, s50, 1179648
    s_waitcnt lgkmcnt(3)
    v_mfma_f32_16x16x32_bf16 v[76:79], v[60:63], a[0:3], 0
    ds_read_b128 v[124:127], v1 offset:38912
    v_mfma_f32_16x16x32_bf16 v[76:79], v[116:119], a[8:11], v[76:79]
    buffer_store_dword v112, v4, s[28:31], s55 offen nt
    v_mfma_f32_16x16x32_bf16 v[76:79], v[40:43], a[16:19], v[76:79]
    ds_read_b128 v[92:95], v0 offset:40960
    v_cvt_pk_bf16_f32 v84, v84, v48
    v_mfma_f32_16x16x32_bf16 v[76:79], v[68:71], a[24:27], v[76:79]
    buffer_store_dword v113, v5, s[28:31], s55 offen nt
    v_mfma_f32_16x16x32_bf16 v[28:31], v[68:71], a[28:31], 0
    ds_read_b128 v[8:11], v1 offset:40960
    v_cvt_pk_bf16_f32 v85, v85, v49
    v_mfma_f32_16x16x32_bf16 v[28:31], v[40:43], a[20:23], v[28:31]
    buffer_store_dword v114, v6, s[28:31], s55 offen nt
    v_mfma_f32_16x16x32_bf16 v[28:31], v[116:119], a[12:15], v[28:31]
    ds_read_b128 v[96:99], v0 offset:43008
    v_cvt_pk_bf16_f32 v86, v86, v50
    v_mfma_f32_16x16x32_bf16 v[28:31], v[60:63], a[4:7], v[28:31]
    v_cvt_pk_bf16_f32 v87, v87, v51
    s_waitcnt lgkmcnt(3)
    v_mfma_f32_16x16x32_bf16 v[28:31], v[100:103], a[36:39], v[28:31]
    ds_read_b128 v[36:39], v1 offset:43008
    v_mfma_f32_16x16x32_bf16 v[28:31], v[88:91], a[44:47], v[28:31]
    buffer_store_dword v115, v7, s[28:31], s55 offen nt
    v_mfma_f32_16x16x32_bf16 v[28:31], v[64:67], a[52:55], v[28:31]
    ds_read_b128 v[56:59], v0 offset:45056
    v_mfma_f32_16x16x32_bf16 v[28:31], v[124:127], a[60:63], v[28:31]
    s_add_u32 s55, s50, 1327104
    v_mfma_f32_16x16x32_bf16 v[76:79], v[124:127], a[56:59], v[76:79]
    ds_read_b128 v[52:55], v1 offset:45056
    v_mfma_f32_16x16x32_bf16 v[76:79], v[64:67], a[48:51], v[76:79]
    buffer_store_dword v120, v4, s[28:31], s55 offen nt
    v_mfma_f32_16x16x32_bf16 v[76:79], v[88:91], a[40:43], v[76:79]
    ds_read_b128 v[72:75], v0 offset:47104
    v_mfma_f32_16x16x32_bf16 v[76:79], v[100:103], a[32:35], v[76:79]
    s_waitcnt lgkmcnt(3)
    v_mfma_f32_16x16x32_bf16 v[76:79], v[92:95], a[64:67], v[76:79]
    ds_read_b128 v[108:111], v1 offset:47104
    v_mfma_f32_16x16x32_bf16 v[76:79], v[8:11], a[72:75], v[76:79]
    buffer_store_dword v121, v5, s[28:31], s55 offen nt
    v_mfma_f32_16x16x32_bf16 v[76:79], v[96:99], a[80:83], v[76:79]
    ds_read_b128 v[32:35], v0 offset:16384
    v_mfma_f32_16x16x32_bf16 v[76:79], v[36:39], a[88:91], v[76:79]
    buffer_store_dword v122, v6, s[28:31], s55 offen nt
    v_mfma_f32_16x16x32_bf16 v[28:31], v[36:39], a[92:95], v[28:31]
    ds_read_b128 v[80:83], v1 offset:16384
    v_mfma_f32_16x16x32_bf16 v[28:31], v[96:99], a[84:87], v[28:31]
    buffer_store_dword v123, v7, s[28:31], s55 offen nt
    v_mfma_f32_16x16x32_bf16 v[28:31], v[8:11], a[76:79], v[28:31]
    ds_read_b128 v[104:107], v0 offset:18432
    v_mfma_f32_16x16x32_bf16 v[28:31], v[92:95], a[68:71], v[28:31]
    s_waitcnt lgkmcnt(3)
    v_mfma_f32_16x16x32_bf16 v[28:31], v[56:59], a[100:103], v[28:31]
    ds_read_b128 v[24:27], v1 offset:18432
    v_mfma_f32_16x16x32_bf16 v[28:31], v[52:55], a[108:111], v[28:31]
    buffer_store_dword v20, v4, s[28:31], s10 offen nt
    v_mfma_f32_16x16x32_bf16 v[28:31], v[72:75], a[116:119], v[28:31]
    ds_read_b128 v[68:71], v0 offset:20480
    v_mfma_f32_16x16x32_bf16 v[28:31], v[108:111], a[124:127], v[28:31]
    buffer_store_dword v21, v5, s[28:31], s10 offen nt
    v_mfma_f32_16x16x32_bf16 v[76:79], v[108:111], a[120:123], v[76:79]
    ds_read_b128 v[40:43], v1 offset:20480
    v_mfma_f32_16x16x32_bf16 v[76:79], v[72:75], a[112:115], v[76:79]
    buffer_store_dword v22, v6, s[28:31], s10 offen nt
    v_mfma_f32_16x16x32_bf16 v[76:79], v[52:55], a[104:107], v[76:79]
    ds_read_b128 v[116:119], v0 offset:22528
    v_mfma_f32_16x16x32_bf16 v[76:79], v[56:59], a[96:99], v[76:79]
    s_waitcnt lgkmcnt(3)
    v_mfma_f32_16x16x32_bf16 v[60:63], v[32:35], a[0:3], 0
    ds_read_b128 v[48:51], v1 offset:22528
    v_mfma_f32_16x16x32_bf16 v[60:63], v[80:83], a[8:11], v[60:63]
    buffer_store_dword v23, v7, s[28:31], s10 offen nt
    v_mfma_f32_16x16x32_bf16 v[60:63], v[104:107], a[16:19], v[60:63]
    ds_read_b128 v[112:115], v0 offset:24576
    v_mfma_f32_16x16x32_bf16 v[60:63], v[24:27], a[24:27], v[60:63]
    buffer_store_dword v16, v4, s[28:31], s11 offen nt
    v_mfma_f32_16x16x32_bf16 v[124:127], v[24:27], a[28:31], 0
    ds_read_b128 v[64:67], v1 offset:24576
    v_cvt_pk_bf16_f32 v76, v76, v28
    v_mfma_f32_16x16x32_bf16 v[124:127], v[104:107], a[20:23], v[124:127]
    buffer_store_dword v17, v5, s[28:31], s11 offen nt
    v_mfma_f32_16x16x32_bf16 v[124:127], v[80:83], a[12:15], v[124:127]
    ds_read_b128 v[88:91], v0 offset:26624
    v_cvt_pk_bf16_f32 v77, v77, v29
    v_mfma_f32_16x16x32_bf16 v[124:127], v[32:35], a[4:7], v[124:127]
    v_cvt_pk_bf16_f32 v78, v78, v30
    s_waitcnt lgkmcnt(3)
    v_mfma_f32_16x16x32_bf16 v[124:127], v[68:71], a[36:39], v[124:127]
    ds_read_b128 v[100:103], v1 offset:26624
    v_cvt_pk_bf16_f32 v79, v79, v31
    v_mfma_f32_16x16x32_bf16 v[124:127], v[40:43], a[44:47], v[124:127]
    buffer_store_dword v18, v6, s[28:31], s11 offen nt
    v_mfma_f32_16x16x32_bf16 v[124:127], v[116:119], a[52:55], v[124:127]
    ds_read_b128 v[36:39], v0 offset:28672
    v_mfma_f32_16x16x32_bf16 v[124:127], v[48:51], a[60:63], v[124:127]
    buffer_store_dword v19, v7, s[28:31], s11 offen nt
    v_mfma_f32_16x16x32_bf16 v[60:63], v[48:51], a[56:59], v[60:63]
    ds_read_b128 v[96:99], v1 offset:28672
    v_mfma_f32_16x16x32_bf16 v[60:63], v[116:119], a[48:51], v[60:63]
    buffer_store_dword v44, v4, s[28:31], s14 offen nt
    v_mfma_f32_16x16x32_bf16 v[60:63], v[40:43], a[40:43], v[60:63]
    ds_read_b128 v[8:11], v0 offset:30720
    v_mfma_f32_16x16x32_bf16 v[60:63], v[68:71], a[32:35], v[60:63]
    s_waitcnt lgkmcnt(3)
    v_mfma_f32_16x16x32_bf16 v[60:63], v[112:115], a[64:67], v[60:63]
    ds_read_b128 v[120:123], v1 offset:30720
    v_mfma_f32_16x16x32_bf16 v[60:63], v[64:67], a[72:75], v[60:63]
    buffer_store_dword v45, v5, s[28:31], s14 offen nt
    v_mfma_f32_16x16x32_bf16 v[60:63], v[88:91], a[80:83], v[60:63]
    v_add_u32 v0, 0x20000, v0
    ds_read_b128 v[92:95], v0 offset:0
    v_mfma_f32_16x16x32_bf16 v[60:63], v[100:103], a[88:91], v[60:63]
    buffer_store_dword v46, v6, s[28:31], s14 offen nt
    v_mfma_f32_16x16x32_bf16 v[124:127], v[100:103], a[92:95], v[124:127]
    v_add_u32 v1, 0x20000, v1
    ds_read_b128 v[108:111], v1 offset:0
    v_mfma_f32_16x16x32_bf16 v[124:127], v[88:91], a[84:87], v[124:127]
    buffer_store_dword v47, v7, s[28:31], s14 offen nt
    v_mfma_f32_16x16x32_bf16 v[124:127], v[64:67], a[76:79], v[124:127]
    ds_read_b128 v[72:75], v0 offset:2048
    v_mfma_f32_16x16x32_bf16 v[124:127], v[112:115], a[68:71], v[124:127]
    s_waitcnt lgkmcnt(3)
    v_mfma_f32_16x16x32_bf16 v[124:127], v[36:39], a[100:103], v[124:127]
    ds_read_b128 v[52:55], v1 offset:2048
    v_mfma_f32_16x16x32_bf16 v[124:127], v[96:99], a[108:111], v[124:127]
    buffer_store_dword v12, v4, s[28:31], s20 offen nt
    v_mfma_f32_16x16x32_bf16 v[124:127], v[8:11], a[116:119], v[124:127]
    ds_read_b128 v[56:59], v0 offset:4096
    v_mfma_f32_16x16x32_bf16 v[124:127], v[120:123], a[124:127], v[124:127]
    buffer_store_dword v13, v5, s[28:31], s20 offen nt
    v_mfma_f32_16x16x32_bf16 v[60:63], v[120:123], a[120:123], v[60:63]
    ds_read_b128 v[20:23], v1 offset:4096
    v_mfma_f32_16x16x32_bf16 v[60:63], v[8:11], a[112:115], v[60:63]
    buffer_store_dword v14, v6, s[28:31], s20 offen nt
    v_mfma_f32_16x16x32_bf16 v[60:63], v[96:99], a[104:107], v[60:63]
    ds_read_b128 v[24:27], v0 offset:6144
    v_mfma_f32_16x16x32_bf16 v[60:63], v[36:39], a[96:99], v[60:63]
    s_waitcnt lgkmcnt(3)
    v_mfma_f32_16x16x32_bf16 v[104:107], v[92:95], a[0:3], 0
    ds_read_b128 v[80:83], v1 offset:6144
    v_mfma_f32_16x16x32_bf16 v[104:107], v[108:111], a[8:11], v[104:107]
    buffer_store_dword v15, v7, s[28:31], s20 offen nt
    v_mfma_f32_16x16x32_bf16 v[104:107], v[72:75], a[16:19], v[104:107]
    ds_read_b128 v[32:35], v0 offset:8192
    v_mfma_f32_16x16x32_bf16 v[104:107], v[52:55], a[24:27], v[104:107]
    buffer_store_dword v84, v4, s[28:31], s21 offen nt
    v_mfma_f32_16x16x32_bf16 v[28:31], v[52:55], a[28:31], 0
    ds_read_b128 v[48:51], v1 offset:8192
    v_cvt_pk_bf16_f32 v60, v60, v124
    v_mfma_f32_16x16x32_bf16 v[28:31], v[72:75], a[20:23], v[28:31]
    buffer_store_dword v85, v5, s[28:31], s21 offen nt
    v_mfma_f32_16x16x32_bf16 v[28:31], v[108:111], a[12:15], v[28:31]
    ds_read_b128 v[16:19], v0 offset:10240
    v_cvt_pk_bf16_f32 v61, v61, v125
    v_mfma_f32_16x16x32_bf16 v[28:31], v[92:95], a[4:7], v[28:31]
    v_cvt_pk_bf16_f32 v62, v62, v126
    s_waitcnt lgkmcnt(3)
    v_mfma_f32_16x16x32_bf16 v[28:31], v[56:59], a[36:39], v[28:31]
    ds_read_b128 v[116:119], v1 offset:10240
    v_cvt_pk_bf16_f32 v63, v63, v127
    v_mfma_f32_16x16x32_bf16 v[28:31], v[20:23], a[44:47], v[28:31]
    buffer_store_dword v86, v6, s[28:31], s21 offen nt
    v_mfma_f32_16x16x32_bf16 v[28:31], v[24:27], a[52:55], v[28:31]
    ds_read_b128 v[40:43], v0 offset:12288
    v_mfma_f32_16x16x32_bf16 v[28:31], v[80:83], a[60:63], v[28:31]
    buffer_store_dword v87, v7, s[28:31], s21 offen nt
    v_mfma_f32_16x16x32_bf16 v[104:107], v[80:83], a[56:59], v[104:107]
    ds_read_b128 v[68:71], v1 offset:12288
    v_mfma_f32_16x16x32_bf16 v[104:107], v[24:27], a[48:51], v[104:107]
    buffer_store_dword v76, v4, s[28:31], s22 offen nt
    v_mfma_f32_16x16x32_bf16 v[104:107], v[20:23], a[40:43], v[104:107]
    ds_read_b128 v[100:103], v0 offset:14336
    v_mfma_f32_16x16x32_bf16 v[104:107], v[56:59], a[32:35], v[104:107]
    s_waitcnt lgkmcnt(3)
    v_mfma_f32_16x16x32_bf16 v[104:107], v[32:35], a[64:67], v[104:107]
    ds_read_b128 v[88:91], v1 offset:14336
    v_mfma_f32_16x16x32_bf16 v[104:107], v[48:51], a[72:75], v[104:107]
    buffer_store_dword v77, v5, s[28:31], s22 offen nt
    v_mfma_f32_16x16x32_bf16 v[104:107], v[16:19], a[80:83], v[104:107]
    ds_read_b128 v[64:67], v0 offset:16384
    v_mfma_f32_16x16x32_bf16 v[104:107], v[116:119], a[88:91], v[104:107]
    buffer_store_dword v78, v6, s[28:31], s22 offen nt
    v_mfma_f32_16x16x32_bf16 v[28:31], v[116:119], a[92:95], v[28:31]
    ds_read_b128 v[44:47], v1 offset:16384
    v_mfma_f32_16x16x32_bf16 v[28:31], v[16:19], a[84:87], v[28:31]
    buffer_store_dword v79, v7, s[28:31], s22 offen nt
    v_mfma_f32_16x16x32_bf16 v[28:31], v[48:51], a[76:79], v[28:31]
    ds_read_b128 v[112:115], v0 offset:18432
    v_mfma_f32_16x16x32_bf16 v[28:31], v[32:35], a[68:71], v[28:31]
    s_waitcnt lgkmcnt(3)
    v_mfma_f32_16x16x32_bf16 v[28:31], v[40:43], a[100:103], v[28:31]
    ds_read_b128 v[120:123], v1 offset:18432
    v_mfma_f32_16x16x32_bf16 v[28:31], v[68:71], a[108:111], v[28:31]
    buffer_store_dword v60, v4, s[28:31], s24 offen nt
    v_mfma_f32_16x16x32_bf16 v[28:31], v[100:103], a[116:119], v[28:31]
    ds_read_b128 v[8:11], v0 offset:20480
    v_mfma_f32_16x16x32_bf16 v[28:31], v[88:91], a[124:127], v[28:31]
    buffer_store_dword v61, v5, s[28:31], s24 offen nt
    v_mfma_f32_16x16x32_bf16 v[104:107], v[88:91], a[120:123], v[104:107]
    ds_read_b128 v[96:99], v1 offset:20480
    v_mfma_f32_16x16x32_bf16 v[104:107], v[100:103], a[112:115], v[104:107]
    buffer_store_dword v62, v6, s[28:31], s24 offen nt
    v_mfma_f32_16x16x32_bf16 v[104:107], v[68:71], a[104:107], v[104:107]
    ds_read_b128 v[36:39], v0 offset:22528
    v_mfma_f32_16x16x32_bf16 v[104:107], v[40:43], a[96:99], v[104:107]
    s_cmp_ge_u32 s37, 2
    s_cbranch_scc0 L_c19
    s_nop 5
    v_cvt_pk_bf16_f32 v104, v104, v28
    buffer_store_dword v63, v7, s[28:31], s24 offen nt
    v_cvt_pk_bf16_f32 v105, v105, v29
    buffer_store_dword v104, v4, s[28:31], s25 offen nt
    v_cvt_pk_bf16_f32 v106, v106, v30
    buffer_store_dword v105, v5, s[28:31], s25 offen nt
    v_cvt_pk_bf16_f32 v107, v107, v31
    buffer_store_dword v106, v6, s[28:31], s25 offen nt
    buffer_store_dword v107, v7, s[28:31], s25 offen nt
    s_endpgm
L_c19:
    s_waitcnt lgkmcnt(3)
    v_mfma_f32_16x16x32_bf16 v[12:15], v[64:67], a[0:3], 0
    ds_read_b128 v[52:55], v1 offset:22528
    v_mfma_f32_16x16x32_bf16 v[12:15], v[44:47], a[8:11], v[12:15]
    buffer_store_dword v63, v7, s[28:31], s24 offen nt
    v_mfma_f32_16x16x32_bf16 v[12:15], v[112:115], a[16:19], v[12:15]
    ds_read_b128 v[72:75], v0 offset:24576
    v_mfma_f32_16x16x32_bf16 v[12:15], v[120:123], a[24:27], v[12:15]
    v_cvt_pk_bf16_f32 v104, v104, v28
    v_mfma_f32_16x16x32_bf16 v[108:111], v[120:123], a[28:31], 0
    ds_read_b128 v[92:95], v1 offset:24576
    v_cvt_pk_bf16_f32 v105, v105, v29
    v_mfma_f32_16x16x32_bf16 v[108:111], v[112:115], a[20:23], v[108:111]
    buffer_store_dword v104, v4, s[28:31], s25 offen nt
    v_mfma_f32_16x16x32_bf16 v[108:111], v[44:47], a[12:15], v[108:111]
    ds_read_b128 v[124:127], v0 offset:26624
    v_cvt_pk_bf16_f32 v106, v106, v30
    v_mfma_f32_16x16x32_bf16 v[108:111], v[64:67], a[4:7], v[108:111]
    v_cvt_pk_bf16_f32 v107, v107, v31
    s_waitcnt lgkmcnt(3)
    v_mfma_f32_16x16x32_bf16 v[108:111], v[8:11], a[36:39], v[108:111]
    ds_read_b128 v[80:83], v1 offset:26624
    v_mfma_f32_16x16x32_bf16 v[108:111], v[96:99], a[44:47], v[108:111]
    buffer_store_dword v105, v5, s[28:31], s25 offen nt
    v_mfma_f32_16x16x32_bf16 v[108:111], v[36:39], a[52:55], v[108:111]
    ds_read_b128 v[84:87], v0 offset:28672
    v_mfma_f32_16x16x32_bf16 v[108:111], v[52:55], a[60:63], v[108:111]
    buffer_store_dword v106, v6, s[28:31], s25 offen nt
    v_mfma_f32_16x16x32_bf16 v[12:15], v[52:55], a[56:59], v[12:15]
    ds_read_b128 v[24:27], v1 offset:28672
    v_mfma_f32_16x16x32_bf16 v[12:15], v[36:39], a[48:51], v[12:15]
    buffer_store_dword v107, v7, s[28:31], s25 offen nt
    v_mfma_f32_16x16x32_bf16 v[12:15], v[96:99], a[40:43], v[12:15]
    ds_read_b128 v[20:23], v0 offset:30720
    v_mfma_f32_16x16x32_bf16 v[12:15], v[8:11], a[32:35], v[12:15]
    s_waitcnt lgkmcnt(3)
    v_mfma_f32_16x16x32_bf16 v[12:15], v[72:75], a[64:67], v[12:15]
    ds_read_b128 v[56:59], v1 offset:30720
    v_mfma_f32_16x16x32_bf16 v[12:15], v[92:95], a[72:75], v[12:15]
    v_mfma_f32_16x16x32_bf16 v[12:15], v[124:127], a[80:83], v[12:15]
    v_mfma_f32_16x16x32_bf16 v[12:15], v[80:83], a[88:91], v[12:15]
    v_mfma_f32_16x16x32_bf16 v[108:111], v[80:83], a[92:95], v[108:111]
    v_mfma_f32_16x16x32_bf16 v[108:111], v[124:127], a[84:87], v[108:111]
    v_mfma_f32_16x16x32_bf16 v[108:111], v[92:95], a[76:79], v[108:111]
    v_mfma_f32_16x16x32_bf16 v[108:111], v[72:75], a[68:71], v[108:111]
    s_waitcnt lgkmcnt(0)
    v_mfma_f32_16x16x32_bf16 v[108:111], v[84:87], a[100:103], v[108:111]
    v_mfma_f32_16x16x32_bf16 v[108:111], v[24:27], a[108:111], v[108:111]
    v_mfma_f32_16x16x32_bf16 v[108:111], v[20:23], a[116:119], v[108:111]
    v_mfma_f32_16x16x32_bf16 v[108:111], v[56:59], a[124:127], v[108:111]
    v_mfma_f32_16x16x32_bf16 v[12:15], v[56:59], a[120:123], v[12:15]
    v_mfma_f32_16x16x32_bf16 v[12:15], v[20:23], a[112:115], v[12:15]
    v_mfma_f32_16x16x32_bf16 v[12:15], v[24:27], a[104:107], v[12:15]
    v_mfma_f32_16x16x32_bf16 v[12:15], v[84:87], a[96:99], v[12:15]
    s_nop 7
    v_cvt_pk_bf16_f32 v12, v12, v108
    v_cvt_pk_bf16_f32 v13, v13, v109
    buffer_store_dword v12, v4, s[28:31], s26 offen nt
    v_cvt_pk_bf16_f32 v14, v14, v110
    buffer_store_dword v13, v5, s[28:31], s26 offen nt
    v_cvt_pk_bf16_f32 v15, v15, v111
    buffer_store_dword v14, v6, s[28:31], s26 offen nt
    buffer_store_dword v15, v7, s[28:31], s26 offen nt
    s_endpgm
L_last:
.fill 512, 4, 0xbf800000
.section .rodata,"a"
.p2align 6
.amdhsa_kernel standalone__normalfloat_lut_nf4__prompt_kernel
  .amdhsa_next_free_vgpr 256
  .amdhsa_next_free_sgpr 102
  .amdhsa_accum_offset 128
  .amdhsa_group_segment_fixed_size 0
  .amdhsa_kernarg_size 48
  .amdhsa_user_sgpr_count 2
  .amdhsa_user_sgpr_kernarg_segment_ptr 1
  .amdhsa_system_sgpr_workgroup_id_x 1
  .amdhsa_float_denorm_mode_32 3
  .amdhsa_float_denorm_mode_16_64 3
.end_amdhsa_kernel
```
